```python
import torch

def _softmax(x, axis=-1):
    return torch.softmax(x, dim=axis)
def _gelu(x):
    return torch.nn.functional.gelu(x, approximate="tanh")
def _silu(x):
    return torch.nn.functional.silu(x)
def _sigmoid(x):
    return torch.sigmoid(x)
def _layernorm(x, axis=-1, eps=1e-5):
    m = x.mean(dim=axis, keepdim=True)
    v = x.var(dim=axis, keepdim=True, unbiased=False)
    return (x - m) / torch.sqrt(v + eps)
def _scatter_add(tgt, idx, src, axis=0):
    return tgt.clone().index_add_(axis, idx, src)
def _segment_sum(src, seg, n):
    out = torch.zeros((n,) + src.shape[1:], dtype=src.dtype)
    return out.index_add_(0, seg, src)
def _pad(x, pw):
    flat = tuple(v for pair in reversed(pw) for v in pair)
    return torch.nn.functional.pad(x, flat)

kernel_name = 'sequential_preLN__ssm_conv_s4d__moe_arch_mod__prompt'

def setup_inputs():

    _w = (lambda a: (lambda t: t.to(torch.bfloat16) if t.is_floating_point() else t)(torch.as_tensor(a)))
    def _A_setup():
        Bsz, L, D, N = 1, 2048, 640, 128
        return {
            "u": _w((lambda *s: torch.randn(*s, dtype=torch.bfloat16) * 0.05)(Bsz, L, D)),
            "log_A_real": _w((lambda *s: torch.randn(*s, dtype=torch.bfloat16) * 6.4)(D, N) * 0.5),
            "A_imag": _w((lambda *s: torch.randn(*s, dtype=torch.bfloat16) * 0.05)(D, N) * 3.14),
            "C_real": _w((lambda *s: torch.randn(*s, dtype=torch.bfloat16) * 0.05)(D, N) / N ** 0.5),
            "C_imag": _w((lambda *s: torch.randn(*s, dtype=torch.bfloat16) * 0.05)(D, N) / N ** 0.5),
            "log_dt": _w((lambda *s: torch.randn(*s, dtype=torch.bfloat16) * 0.05)(D) * 0.5 - 4.0),
            "D_skip": _w((lambda *s: torch.randn(*s, dtype=torch.bfloat16) * 0.05)(D)),
        }
    _A_in = _A_setup()

    def _B_setup():
        B, S, D, F, C = 1, 2048, 640, 1728, 1
        return {
            "x": _w((lambda *s: torch.randn(*s, dtype=torch.bfloat16) * 0.05)(B, S, D)),
            "w_r": _w((lambda *s: torch.randn(*s, dtype=torch.bfloat16) * 0.05)(D)),
            "w_gate": _w((lambda *s: torch.randn(*s, dtype=torch.bfloat16) * 0.05)(D, F)),
            "w_up": _w((lambda *s: torch.randn(*s, dtype=torch.bfloat16) * 0.05)(D, F)),
            "w_down": _w((lambda *s: torch.randn(*s, dtype=torch.bfloat16) * 0.05)(F, D)),
        }
    _B_in = _B_setup()

    return {
        "A_u": _A_in["u"],
        "A_log_A_real": _A_in["log_A_real"],
        "A_A_imag": _A_in["A_imag"],
        "A_C_real": _A_in["C_real"],
        "A_C_imag": _A_in["C_imag"],
        "A_log_dt": _A_in["log_dt"],
        "A_D_skip": _A_in["D_skip"],
        "B_x": _B_in["x"],
        "B_w_r": _B_in["w_r"],
        "B_w_gate": _B_in["w_gate"],
        "B_w_up": _B_in["w_up"],
        "B_w_down": _B_in["w_down"],
    }

def reference(A_u, A_log_A_real, A_A_imag, A_C_real, A_C_imag, A_log_dt, A_D_skip, B_x, B_w_r, B_w_gate, B_w_up, B_w_down):
    def _A_ref(u, log_A_real, A_imag, C_real, C_imag, log_dt, D_skip):
        L = u.shape[1]
        dt = torch.exp(log_dt)
        A = -torch.exp(log_A_real) + 1j * A_imag
        C = (C_real + 1j * C_imag) * dt[:, None]
        pos = (lambda x, dt: x.to(dt))(torch.arange(L), log_dt.dtype)
        P = torch.exp((A * dt[:, None])[:, :, None] * pos[None, None, :])
        K = 2.0 * torch.einsum("dn,dnl->dl", C, P).real
        L2 = 2 * L
        u_t = (lambda x, *d: x.permute(*d))(u, 0, 2, 1)
        Kf = (lambda x, *a, **k: torch.fft.rfft(x.float(), *a, **k))(K, L2)
        Uf = (lambda x, *a, **k: torch.fft.rfft(x.float(), *a, **k))(u_t, L2)
        y = (lambda x, *a, **k: torch.fft.irfft(x, *a, **k).to(torch.bfloat16))(Uf * Kf[None, :, :], L2)[:, :, :L]
        y = (lambda x, *d: x.permute(*d))(y, 0, 2, 1)
        return y + u * D_skip[None, None, :]

    def _B_ref(x, w_r, w_gate, w_up, w_down):
        B, S, D = x.shape
        C = 1
        r = x @ w_r
        idx = torch.argsort(-r, axis=-1)[:, :C]
        idx_e = (lambda x, n, axis: torch.repeat_interleave(x, n, dim=axis))(idx.reshape(B, C, 1), D, axis=2)
        x_sel = (lambda x, i, axis: torch.take_along_dim(x, i, dim=axis))(x, idx_e, axis=1)
        g = _silu(x_sel @ w_gate)
        u = x_sel @ w_up
        y = (g * u) @ w_down
        r_sel = _sigmoid((lambda x, i, axis: torch.take_along_dim(x, i, dim=axis))(r, idx, axis=1))
        y = y * r_sel.reshape(B, C, 1)
        b_off = (torch.arange(B) * S).reshape(B, 1)
        flat_idx = (idx + b_off).reshape(B * C)
        zero = (x * 0.0).reshape(B * S, D)
        upd = _scatter_add(zero, flat_idx, y.reshape(B * C, D), axis=0)
        return x + upd.reshape(B, S, D)

    x = A_u
    h = x + _A_ref(_layernorm(x, axis=-1), A_log_A_real, A_A_imag, A_C_real, A_C_imag, A_log_dt, A_D_skip)
    h2 = h + _B_ref(_layernorm(h, axis=-1), B_w_r, B_w_gate, B_w_up, B_w_down)
    return h2
```

```asm
; @launch grid=(256,1,1) block=(512,1,1) lds=124704
.amdgcn_target "amdgcn-amd-amdhsa--gfx950"
.text
.globl sequential_preLN__ssm_conv_s4d__moe_arch_mod__prompt_kernel
.p2align 8
.type sequential_preLN__ssm_conv_s4d__moe_arch_mod__prompt_kernel,@function
sequential_preLN__ssm_conv_s4d__moe_arch_mod__prompt_kernel:
    s_cmp_ge_u32 s2, 256
    s_cbranch_scc1 L_endx
    s_load_dwordx8 s[4:11], s[0:1], 0
    s_load_dwordx4 s[12:15], s[0:1], 32
    s_load_dwordx2 s[16:17], s[0:1], 48
    s_load_dwordx2 s[18:19], s[0:1], 112
    s_load_dwordx8 s[64:71], s[0:1], 64
    s_load_dwordx4 s[72:75], s[0:1], 96
    v_lshrrev_b32 v1, 6, v0
    v_and_b32 v2, 63, v0
    v_readfirstlane_b32 s20, v1
    s_and_b32 s21, s2, 7
    s_lshl_b32 s21, s21, 5
    s_lshr_b32 s22, s2, 3
    s_add_u32 s21, s21, s22
    s_lshl_b32 s22, s21, 3
    s_add_u32 s22, s22, s20
    s_mul_i32 s23, s22, 1280
    v_lshlrev_b32 v3, 4, v2
    v_lshlrev_b32 v4, 2, v2
    s_and_b32 s60, s2, 7
    s_lshl_b32 s60, s60, 4
    s_lshr_b32 s61, s2, 4
    s_add_u32 s3, s60, s61
    s_mul_i32 s60, s3, 5
    s_bfe_u32 s61, s2, 0x10003
    s_lshl_b32 s100, s3, 12
    s_add_u32 s100, s100, 4718592
    s_lshl_b32 s3, s3, 1
    s_add_u32 s3, s3, s61
    s_lshl_b32 s3, s3, 13
    s_add_u32 s3, s3, 2621440
    s_mul_i32 s62, s61, 3
    s_add_u32 s62, s62, s60
    s_add_u32 s63, s60, 2
    s_lshr_b32 s56, s20, 1
    s_add_u32 s57, s62, s56
    s_cmp_eq_u32 s56, 2
    s_cselect_b32 s57, s63, s57
    s_cmp_lg_u32 s20, 6
    s_cbranch_scc1 L_cp_1
    s_getpc_b64 s[24:25]
    L_pc_here:
    s_lshr_b32 s26, s2, 3
    s_lshl_b32 s26, s26, 10
    v_add_u32 v5, s26, v3
    s_cmp_lt_u32 s26, (L_endx - L_pc_here) & 0xfffffc00
    s_cbranch_scc0 L_cp_1
    global_load_dwordx4 v[240:243], v5, s[24:25]
L_cp_1:
    s_waitcnt lgkmcnt(0)
    s_mov_b32 s24, s4
    s_and_b32 s25, s5, 0xffff
    s_mov_b32 s26, 2621440
    s_mov_b32 s27, 0x00020000
    s_mov_b32 s32, s18
    s_and_b32 s33, s19, 0xffff
    s_mov_b32 s34, 16777216
    s_mov_b32 s35, 0x00020000
    s_mov_b32 s28, s16
    s_and_b32 s29, s17, 0xffff
    s_mov_b32 s30, 1280
    s_mov_b32 s31, 0x00020000
    s_lshl_b32 s17, s2, 3
    s_add_u32 s17, s17, s20
    s_cmp_lg_u32 s17, 7
    s_cbranch_scc1 L_nz_2
    v_mov_b32 v8, 0
    v_mov_b32 v9, 0
    v_mov_b32 v10, 0
    v_mov_b32 v11, 0
    s_mov_b32 s4, 5251072
    buffer_store_dwordx4 v[8:11], v3, s[32:35], s4 offen sc1
    buffer_store_dwordx4 v[8:11], v3, s[32:35], s4 offen offset:1024 sc1
    buffer_store_dwordx4 v[8:11], v3, s[32:35], s4 offen offset:2048 sc1
    buffer_store_dwordx4 v[8:11], v3, s[32:35], s4 offen offset:3072 sc1
    v_lshlrev_b32 v12, 12, v2
    s_mov_b32 s4, 5275904
    s_mov_b64 exec, 0xff
    buffer_store_dword v8, v12, s[32:35], s4 offen sc1
    s_mov_b64 exec, -1
    s_nop 1
L_nz_2:
    buffer_load_dwordx4 v[8:11], v3, s[24:27], s23 offen
    buffer_load_dword v12, v4, s[24:27], s23 offen offset:1024
    s_mov_b32 s36, s6
    s_and_b32 s37, s7, 0xffff
    s_mov_b32 s38, 163840
    s_mov_b32 s39, 0x00020000
    s_mov_b32 s40, s8
    s_and_b32 s41, s9, 0xffff
    s_mov_b32 s42, 163840
    s_mov_b32 s43, 0x00020000
    s_mov_b32 s44, s10
    s_and_b32 s45, s11, 0xffff
    s_mov_b32 s46, 163840
    s_mov_b32 s47, 0x00020000
    s_mov_b32 s48, s12
    s_and_b32 s49, s13, 0xffff
    s_mov_b32 s50, 163840
    s_mov_b32 s51, 0x00020000
    s_mov_b32 s52, s14
    s_and_b32 s53, s15, 0xffff
    s_mov_b32 s54, 1280
    s_mov_b32 s55, 0x00020000
    buffer_load_dwordx4 v[14:17], v3, s[28:31], 0 offen
    buffer_load_dword v18, v4, s[28:31], 0 offen offset:1024
    s_lshl_b32 s58, s57, 8
    s_and_b32 s59, s20, 1
    s_lshl_b32 s59, s59, 7
    s_add_u32 s59, s59, s58
    v_lshlrev_b32 v5, 1, v2
    s_lshl_b32 s16, s57, 1
    v_mov_b32 v6, 0
    buffer_load_ushort v20, v5, s[36:39], s59 offen
    buffer_load_ushort v21, v5, s[40:43], s59 offen
    buffer_load_ushort v22, v5, s[44:47], s59 offen
    buffer_load_ushort v23, v5, s[48:51], s59 offen
    buffer_load_dword v24, v4, s[44:47], s58 offen
    buffer_load_dword v25, v4, s[48:51], s58 offen
    buffer_load_ushort v26, v6, s[52:55], s16 offen
    s_cmp_ge_u32 s20, 6
    s_cbranch_scc1 L_nw_3
    v_lshlrev_b32 v27, 21, v2
    s_mov_b32 s8, 0
    s_mov_b32 s4, s18
    s_mov_b32 s5, s19
    s_mov_b32 s6, 8388608
    s_cmp_eq_u32 s20, 1
    s_cselect_b32 s4, s72, s4
    s_cselect_b32 s5, s73, s5
    s_cselect_b32 s6, 2621440, s6
    s_cmp_eq_u32 s20, 2
    s_cselect_b32 s4, s74, s4
    s_cselect_b32 s5, s75, s5
    s_cselect_b32 s6, 256, s6
    s_cmp_eq_u32 s20, 3
    s_cselect_b32 s4, s64, s4
    s_cselect_b32 s5, s65, s5
    s_cselect_b32 s6, 1280, s6
    s_cmp_eq_u32 s20, 4
    s_cselect_b32 s4, s66, s4
    s_cselect_b32 s5, s67, s5
    s_cselect_b32 s6, 2211840, s6
    s_cmp_eq_u32 s20, 5
    s_cselect_b32 s8, 134217728, s8
    s_and_b32 s5, s5, 0xffff
    s_mov_b32 s7, 0x00020000
    buffer_load_dword v244, v27, s[4:7], s8 offen
L_nw_3:
    s_cmp_lg_u32 s17, 7
    s_cbranch_scc1 L_nr_4
    s_mov_b32 s4, s74
    s_and_b32 s5, s75, 0xffff
    s_mov_b32 s6, 256
    s_mov_b32 s7, 0x00020000
    v_mov_b32 v27, 0
    v_mov_b32 v28, 1
    s_waitcnt vmcnt(11)
    s_mov_b64 exec, 1
    buffer_store_dword v28, v27, s[4:7], 0 offen sc1
    s_mov_b64 exec, -1
L_nr_4:
    v_mov_b32 v27, 0
    v_lshrrev_b32 v28, 5, v0
    v_mul_u32_u24 v28, 1152, v28
    v_and_b32 v29, 31, v0
    v_lshl_add_u32 v28, v29, 2, v28
    v_add_u32 v28, 107808, v28
    v_cmp_gt_u32 vcc, 384, v0
    s_and_saveexec_b64 s[4:5], vcc
    ds_write_b32 v28, v27
    s_mov_b64 exec, s[4:5]
    v_lshrrev_b32 v28, 2, v0
    v_mul_u32_u24 v28, 1344, v28
    v_and_b32 v29, 3, v0
    v_lshl_add_u32 v28, v29, 2, v28
    v_add_u32 v28, 103776, v28
    v_lshlrev_b32 v29, 2, v0
    v_add_u32 v29, 121632, v29
    v_cmp_gt_u32 vcc, 12, v0
    s_and_saveexec_b64 s[4:5], vcc
    ds_write_b32 v28, v27
    ds_write_b32 v29, v27
    ds_write_b32 v29, v27 offset:96
    s_mov_b64 exec, s[4:5]
    v_lshlrev_b32 v5, 2, v0
    v_mov_b32 v27, 103776
    v_add_u32 v31, -3, v5
    v_cvt_f32_i32 v32, v31
    v_cvt_pk_bf16_f32 v32, v32, v32
    v_and_b32 v32, 0xffff, v32
    v_subrev_u32 v32, 17024, v32
    v_cmp_gt_i32 vcc, 256, v31
    s_nop 1
    v_cndmask_b32 v32, v32, v31, vcc
    v_lshl_add_u32 v32, v32, 1, v27
    v_add_u32 v32, 16, v32
    v_cmp_gt_i32 vcc, 0, v31
    s_nop 1
    v_cndmask_b32 v152, v32, v27, vcc
    v_add_u32 v31, -2, v5
    v_cvt_f32_i32 v32, v31
    v_cvt_pk_bf16_f32 v32, v32, v32
    v_and_b32 v32, 0xffff, v32
    v_subrev_u32 v32, 17024, v32
    v_cmp_gt_i32 vcc, 256, v31
    s_nop 1
    v_cndmask_b32 v32, v32, v31, vcc
    v_lshl_add_u32 v32, v32, 1, v27
    v_add_u32 v32, 16, v32
    v_cmp_gt_i32 vcc, 0, v31
    s_nop 1
    v_cndmask_b32 v153, v32, v27, vcc
    v_add_u32 v31, -1, v5
    v_cvt_f32_i32 v32, v31
    v_cvt_pk_bf16_f32 v32, v32, v32
    v_and_b32 v32, 0xffff, v32
    v_subrev_u32 v32, 17024, v32
    v_cmp_gt_i32 vcc, 256, v31
    s_nop 1
    v_cndmask_b32 v32, v32, v31, vcc
    v_lshl_add_u32 v32, v32, 1, v27
    v_add_u32 v32, 16, v32
    v_cmp_gt_i32 vcc, 0, v31
    s_nop 1
    v_cndmask_b32 v154, v32, v27, vcc
    v_add_u32 v31, 0, v5
    v_cvt_f32_i32 v32, v31
    v_cvt_pk_bf16_f32 v32, v32, v32
    v_and_b32 v32, 0xffff, v32
    v_subrev_u32 v32, 17024, v32
    v_cmp_gt_i32 vcc, 256, v31
    s_nop 1
    v_cndmask_b32 v32, v32, v31, vcc
    v_lshl_add_u32 v32, v32, 1, v27
    v_add_u32 v32, 16, v32
    v_cmp_gt_i32 vcc, 0, v31
    s_nop 1
    v_cndmask_b32 v155, v32, v27, vcc
    v_add_u32 v31, 1, v5
    v_cvt_f32_i32 v32, v31
    v_cvt_pk_bf16_f32 v32, v32, v32
    v_and_b32 v32, 0xffff, v32
    v_subrev_u32 v32, 17024, v32
    v_cmp_gt_i32 vcc, 256, v31
    s_nop 1
    v_cndmask_b32 v32, v32, v31, vcc
    v_lshl_add_u32 v32, v32, 1, v27
    v_add_u32 v32, 16, v32
    v_cmp_gt_i32 vcc, 0, v31
    s_nop 1
    v_cndmask_b32 v156, v32, v27, vcc
    v_add_u32 v31, 2, v5
    v_cvt_f32_i32 v32, v31
    v_cvt_pk_bf16_f32 v32, v32, v32
    v_and_b32 v32, 0xffff, v32
    v_subrev_u32 v32, 17024, v32
    v_cmp_gt_i32 vcc, 256, v31
    s_nop 1
    v_cndmask_b32 v32, v32, v31, vcc
    v_lshl_add_u32 v32, v32, 1, v27
    v_add_u32 v32, 16, v32
    v_cmp_gt_i32 vcc, 0, v31
    s_nop 1
    v_cndmask_b32 v157, v32, v27, vcc
    v_add_u32 v31, 3, v5
    v_cvt_f32_i32 v32, v31
    v_cvt_pk_bf16_f32 v32, v32, v32
    v_and_b32 v32, 0xffff, v32
    v_subrev_u32 v32, 17024, v32
    v_cmp_gt_i32 vcc, 256, v31
    s_nop 1
    v_cndmask_b32 v32, v32, v31, vcc
    v_lshl_add_u32 v32, v32, 1, v27
    v_add_u32 v32, 16, v32
    v_cmp_gt_i32 vcc, 0, v31
    s_nop 1
    v_cndmask_b32 v158, v32, v27, vcc
    v_lshrrev_b32 v31, 3, v0
    v_mul_u32_u24 v31, 4224, v31
    v_and_b32 v32, 7, v0
    v_lshl_add_u32 v164, v32, 2, v31
    v_add_u32 v31, 0, v0
    v_mul_u32_u24 v32, 43691, v31
    v_lshrrev_b32 v32, 17, v32
    v_mul_u32_u24 v33, 3, v32
    v_sub_u32 v33, v31, v33
    v_mul_u32_u24 v160, 10240, v32
    v_lshl_add_u32 v160, v33, 4, v160
    s_lshl_b32 s5, s61, 1
    v_add_u32 v33, s5, v33
    v_subrev_u32 v161, 3, v33
    v_cmp_gt_u32 vcc, 3, v33
    s_nop 1
    v_cndmask_b32 v33, v161, v33, vcc
    v_mul_u32_u24 v161, 4608, v33
    v_lshl_add_u32 v161, v32, 2, v161
    v_add_u32 v161, 107936, v161
    v_add_u32 v31, 512, v0
    v_mul_u32_u24 v32, 43691, v31
    v_lshrrev_b32 v32, 17, v32
    v_mul_u32_u24 v33, 3, v32
    v_sub_u32 v33, v31, v33
    v_mul_u32_u24 v162, 10240, v32
    v_lshl_add_u32 v162, v33, 4, v162
    s_lshl_b32 s5, s61, 1
    v_add_u32 v33, s5, v33
    v_subrev_u32 v163, 3, v33
    v_cmp_gt_u32 vcc, 3, v33
    s_nop 1
    v_cndmask_b32 v33, v163, v33, vcc
    v_mul_u32_u24 v163, 4608, v33
    v_lshl_add_u32 v163, v32, 2, v163
    v_add_u32 v163, 107936, v163
    v_mov_b32 v31, 0x7ffffff0
    v_cmp_gt_u32 vcc, 256, v0
    s_nop 1
    v_cndmask_b32 v162, v31, v162, vcc
    v_mov_b32 v36, 0
    v_mov_b32 v37, 0
    v_mov_b32 v38, 0
    v_mov_b32 v39, 0
    v_lshlrev_b32 v35, 4, v0
    buffer_store_dwordx4 v[36:39], v35, s[32:35], s3 offen sc1
    v_lshrrev_b32 v32, 5, v0
    v_mov_b32 v33, 0x8f
    v_mov_b32 v34, 0x70
    s_cmp_eq_u32 s61, 0
    s_cselect_b64 vcc, -1, 0
    v_cndmask_b32 v33, v34, v33, vcc
    v_lshrrev_b32 v33, v32, v33
    v_and_b32 v33, 1, v33
    v_cmp_ne_u32 vcc, 0, v33
    v_mov_b32 v33, 0x7ffffff0
    s_nop 0
    v_cndmask_b32 v35, v33, v35, vcc
    buffer_store_dwordx4 v[36:39], v35, s[32:35], s100 offen sc1
    s_waitcnt vmcnt(11)
    s_mov_b32 s24, s74
    s_and_b32 s25, s75, 0xffff
    s_mov_b32 s26, 256
    s_mov_b32 s27, 0x00020000
    v_lshlrev_b32 v30, 16, v8
    v_and_b32 v31, 0xffff0000, v8
    v_mov_b32 v200, v8
    v_lshlrev_b32 v32, 16, v9
    v_and_b32 v33, 0xffff0000, v9
    v_mov_b32 v201, v9
    v_lshlrev_b32 v34, 16, v10
    v_and_b32 v35, 0xffff0000, v10
    v_mov_b32 v202, v10
    v_lshlrev_b32 v36, 16, v11
    v_and_b32 v37, 0xffff0000, v11
    v_mov_b32 v203, v11
    v_lshlrev_b32 v38, 16, v12
    v_and_b32 v39, 0xffff0000, v12
    v_mov_b32 v204, v12
    v_readfirstlane_b32 s6, v30
    s_nop 1
    v_subrev_f32 v44, s6, v30
    v_subrev_f32 v45, s6, v31
    v_subrev_f32 v46, s6, v32
    v_subrev_f32 v47, s6, v33
    v_subrev_f32 v48, s6, v34
    v_subrev_f32 v49, s6, v35
    v_subrev_f32 v50, s6, v36
    v_subrev_f32 v51, s6, v37
    v_subrev_f32 v52, s6, v38
    v_subrev_f32 v53, s6, v39
    v_add_f32 v40, v44, v45
    v_mul_f32 v43, v44, v44
    v_add_f32 v41, v46, v47
    v_mul_f32 v42, v45, v45
    v_add_f32 v40, v40, v48
    v_add_f32 v41, v41, v49
    v_add_f32 v40, v40, v50
    v_add_f32 v41, v41, v51
    v_add_f32 v40, v40, v52
    v_add_f32 v41, v41, v53
    v_fmac_f32 v43, v46, v46
    v_fmac_f32 v42, v47, v47
    v_fmac_f32 v43, v48, v48
    v_fmac_f32 v42, v49, v49
    v_fmac_f32 v43, v50, v50
    v_fmac_f32 v42, v51, v51
    v_fmac_f32 v43, v52, v52
    v_fmac_f32 v42, v53, v53
    v_add_f32 v40, v40, v41
    v_add_f32 v43, v43, v42
    s_nop 0
    v_add_f32_dpp v40, v40, v40 quad_perm:[1,0,3,2] row_mask:0xf bank_mask:0xf
    v_add_f32_dpp v43, v43, v43 quad_perm:[1,0,3,2] row_mask:0xf bank_mask:0xf
    s_nop 0
    v_add_f32_dpp v40, v40, v40 quad_perm:[2,3,0,1] row_mask:0xf bank_mask:0xf
    v_add_f32_dpp v43, v43, v43 quad_perm:[2,3,0,1] row_mask:0xf bank_mask:0xf
    s_nop 0
    v_add_f32_dpp v40, v40, v40 row_half_mirror row_mask:0xf bank_mask:0xf
    v_add_f32_dpp v43, v43, v43 row_half_mirror row_mask:0xf bank_mask:0xf
    s_nop 0
    v_add_f32_dpp v40, v40, v40 row_mirror row_mask:0xf bank_mask:0xf
    v_add_f32_dpp v43, v43, v43 row_mirror row_mask:0xf bank_mask:0xf
    s_nop 0
    v_add_f32_dpp v40, v40, v40 row_bcast:15 row_mask:0xa bank_mask:0xf
    v_add_f32_dpp v43, v43, v43 row_bcast:15 row_mask:0xa bank_mask:0xf
    s_nop 0
    v_add_f32_dpp v40, v40, v40 row_bcast:31 row_mask:0xc bank_mask:0xf
    v_add_f32_dpp v43, v43, v43 row_bcast:31 row_mask:0xc bank_mask:0xf
    v_mov_b32 v54, 0x3acccccd
    v_readlane_b32 s4, v40, 63
    v_readlane_b32 s5, v43, 63
    s_nop 0
    v_mul_f32 v41, s4, v54
    v_mul_f32 v42, s5, v54
    v_fma_f32 v42, -v41, v41, v42
    v_add_f32 v41, s6, v41
    v_max_f32 v42, 0, v42
    v_cvt_pk_bf16_f32 v54, v42, v42
    v_lshlrev_b32 v42, 16, v54
    v_add_f32 v42, 0x3727c5ac, v42
    v_cvt_pk_bf16_f32 v54, v42, v42
    v_lshlrev_b32 v42, 16, v54
    v_sqrt_f32 v42, v42
    s_nop 0
    v_cvt_pk_bf16_f32 v54, v42, v42
    v_lshlrev_b32 v42, 16, v54
    v_rcp_f32 v42, v42
    v_cvt_pk_bf16_f32 v54, v41, v41
    v_lshlrev_b32 v41, 16, v54
    s_waitcnt vmcnt(9)
    v_lshlrev_b32 v54, 16, v14
    v_and_b32 v55, 0xffff0000, v14
    v_lshlrev_b32 v56, 16, v15
    v_and_b32 v57, 0xffff0000, v15
    v_lshlrev_b32 v58, 16, v16
    v_and_b32 v59, 0xffff0000, v16
    v_lshlrev_b32 v60, 16, v17
    v_and_b32 v61, 0xffff0000, v17
    v_lshlrev_b32 v62, 16, v18
    v_and_b32 v63, 0xffff0000, v18
    v_sub_f32 v30, v30, v41
    v_sub_f32 v31, v31, v41
    v_cvt_pk_bf16_f32 v44, v30, v31
    v_lshlrev_b32 v30, 16, v44
    v_and_b32 v31, 0xffff0000, v44
    v_mul_f32 v30, v30, v42
    v_mul_f32 v31, v31, v42
    v_cvt_pk_bf16_f32 v44, v30, v31
    v_lshlrev_b32 v30, 16, v44
    v_and_b32 v31, 0xffff0000, v44
    v_cvt_pk_f16_f32 v64, v30, v31
    v_sub_f32 v32, v32, v41
    v_sub_f32 v33, v33, v41
    v_cvt_pk_bf16_f32 v44, v32, v33
    v_lshlrev_b32 v32, 16, v44
    v_and_b32 v33, 0xffff0000, v44
    v_mul_f32 v32, v32, v42
    v_mul_f32 v33, v33, v42
    v_cvt_pk_bf16_f32 v44, v32, v33
    v_lshlrev_b32 v32, 16, v44
    v_and_b32 v33, 0xffff0000, v44
    v_cvt_pk_f16_f32 v65, v32, v33
    v_sub_f32 v34, v34, v41
    v_sub_f32 v35, v35, v41
    v_cvt_pk_bf16_f32 v44, v34, v35
    v_lshlrev_b32 v34, 16, v44
    v_and_b32 v35, 0xffff0000, v44
    v_mul_f32 v34, v34, v42
    v_mul_f32 v35, v35, v42
    v_cvt_pk_bf16_f32 v44, v34, v35
    v_lshlrev_b32 v34, 16, v44
    v_and_b32 v35, 0xffff0000, v44
    v_cvt_pk_f16_f32 v66, v34, v35
    v_sub_f32 v36, v36, v41
    v_sub_f32 v37, v37, v41
    v_cvt_pk_bf16_f32 v44, v36, v37
    v_lshlrev_b32 v36, 16, v44
    v_and_b32 v37, 0xffff0000, v44
    v_mul_f32 v36, v36, v42
    v_mul_f32 v37, v37, v42
    v_cvt_pk_bf16_f32 v44, v36, v37
    v_lshlrev_b32 v36, 16, v44
    v_and_b32 v37, 0xffff0000, v44
    v_cvt_pk_f16_f32 v67, v36, v37
    v_sub_f32 v38, v38, v41
    v_sub_f32 v39, v39, v41
    v_cvt_pk_bf16_f32 v44, v38, v39
    v_lshlrev_b32 v38, 16, v44
    v_and_b32 v39, 0xffff0000, v44
    v_mul_f32 v38, v38, v42
    v_mul_f32 v39, v39, v42
    v_cvt_pk_bf16_f32 v44, v38, v39
    v_lshlrev_b32 v38, 16, v44
    v_and_b32 v39, 0xffff0000, v44
    v_cvt_pk_f16_f32 v68, v38, v39
    s_and_b32 s4, s20, 3
    s_lshl_b32 s4, s4, 1
    s_lshr_b32 s5, s20, 2
    s_or_b32 s4, s4, s5
    s_mul_i32 s4, s4, 1344
    s_add_u32 s4, s4, 93024
    v_add_u32 v44, s4, v3
    v_add_u32 v45, s4, v4
    ds_write_b128 v44, v[64:67]
    ds_write_b32 v45, v68 offset:1024
    v_mul_f32 v30, v30, v54
    v_mul_f32 v31, v31, v55
    v_cvt_pk_bf16_f32 v206, v30, v31
    v_mul_f32 v32, v32, v56
    v_mul_f32 v33, v33, v57
    v_cvt_pk_bf16_f32 v207, v32, v33
    v_mul_f32 v34, v34, v58
    v_mul_f32 v35, v35, v59
    v_cvt_pk_bf16_f32 v208, v34, v35
    v_mul_f32 v36, v36, v60
    v_mul_f32 v37, v37, v61
    v_cvt_pk_bf16_f32 v209, v36, v37
    v_mul_f32 v38, v38, v62
    v_mul_f32 v39, v39, v63
    v_cvt_pk_bf16_f32 v210, v38, v39
    v_lshrrev_b32 v44, 2, v2
    v_and_b32 v44, 3, v44
    v_mul_u32_u24 v44, 1344, v44
    v_lshrrev_b32 v45, 4, v2
    v_lshlrev_b32 v45, 5, v45
    v_add_u32 v44, v44, v45
    v_and_b32 v45, 3, v2
    v_lshlrev_b32 v45, 3, v45
    v_add_u32 v44, v44, v45
    s_sub_u32 s6, s20, 2
    s_cmp_lt_u32 s20, 6
    s_cselect_b32 s6, s20, s6
    s_lshl_b32 s4, s6, 7
    s_add_u32 s4, s4, 93024
    v_add_u32 v44, s4, v44
    s_mul_i32 s4, s21, 10240
    s_lshl_b32 s5, s6, 10
    s_add_u32 s4, s4, s5
    s_add_u32 s4, s4, 0
    v_mov_b32 v46, 0
    buffer_load_dword v49, v46, s[24:27], 0 offen sc1
    s_waitcnt lgkmcnt(0)
    s_barrier
    s_lshr_b32 s5, s20, 1
    s_cmp_eq_u32 s5, 2
    s_cbranch_scc1 L_w45_6
    ds_read_b64_tr_b16 v[64:65], v44
    ds_read_b64_tr_b16 v[66:67], v44 offset:5376
    s_cmp_lt_u32 s20, 6
    s_cbranch_scc1 L_w67_5
    ds_read_b64_tr_b16 v[68:69], v44 offset:256
    ds_read_b64_tr_b16 v[70:71], v44 offset:5632
    ds_read_b64_tr_b16 v[72:73], v44 offset:512
    ds_read_b64_tr_b16 v[74:75], v44 offset:5888
    s_add_u32 s5, s4, 4096
    s_waitcnt lgkmcnt(2)
    buffer_store_dwordx4 v[68:71], v3, s[32:35], s4 offen offset:2048 sc1
    s_waitcnt lgkmcnt(0)
    buffer_store_dwordx4 v[72:75], v3, s[32:35], s5 offen sc1
L_w67_5:
    s_waitcnt lgkmcnt(0)
    buffer_store_dwordx4 v[64:67], v3, s[32:35], s4 offen sc1
L_w45_6:
    s_cmp_ge_u32 s20, 6
    s_cbranch_scc1 L_pf_8
    s_mov_b32 s8, 0x3fb8aa3b
    s_mov_b32 s9, 0x32a57060
    s_mov_b32 s10, 0x3f317218
    s_mov_b32 s11, 0x3e22f983
    s_waitcnt vmcnt(4)
    v_lshlrev_b32 v20, 16, v20
    v_lshlrev_b32 v21, 16, v21
    v_lshlrev_b32 v22, 16, v22
    v_lshlrev_b32 v23, 16, v23
    v_lshlrev_b32 v26, 16, v26
    v_and_b32 v24, 0x7f807f80, v24
    v_and_b32 v25, 0x7f807f80, v25
    v_pk_max_u16 v24, v24, v25
    v_lshrrev_b32 v25, 16, v24
    v_and_b32 v24, 0xffff, v24
    v_max_u32 v24, v24, v25
    s_nop 1
    v_max_u32_dpp v24, v24, v24 quad_perm:[1,0,3,2] row_mask:0xf bank_mask:0xf
    s_nop 1
    v_max_u32_dpp v24, v24, v24 quad_perm:[2,3,0,1] row_mask:0xf bank_mask:0xf
    s_nop 1
    v_max_u32_dpp v24, v24, v24 row_half_mirror row_mask:0xf bank_mask:0xf
    s_nop 1
    v_max_u32_dpp v24, v24, v24 row_mirror row_mask:0xf bank_mask:0xf
    s_nop 1
    v_max_u32_dpp v24, v24, v24 row_bcast:15 row_mask:0xa bank_mask:0xf
    s_nop 1
    v_max_u32_dpp v24, v24, v24 row_bcast:31 row_mask:0xc bank_mask:0xf
    s_cmp_lt_u32 s20, 4
    s_cbranch_scc1 L_sk4_9
    s_waitcnt vmcnt(0)
    v_mov_b32 v46, 121632
    v_mov_b32 v47, 1
    s_mov_b64 exec, 1
    ds_add_rtn_u32 v48, v46, v47
    s_waitcnt lgkmcnt(0)
    v_readfirstlane_b32 s4, v48
    s_lshl_b32 s5, s2, 4
    s_add_u32 s5, s5, 5251072
    s_cmp_lg_u32 s4, 7
    s_cbranch_scc1 L_sig_10
    v_mov_b32 v46, 0
    v_cmp_ne_u32 vcc, 0, v49
    s_cbranch_vccnz L_rdy_11
    s_mov_b32 s4, 0
L_spin_12:
    buffer_load_dword v48, v46, s[24:27], 0 offen sc1
    s_waitcnt vmcnt(0)
    v_cmp_ne_u32 vcc, 0, v48
    s_add_u32 s4, s4, 1
    s_cmp_ge_u32 s4, 262144
    s_cbranch_scc1 L_spinout_13
    s_cmp_eq_u64 vcc, exec
    s_cbranch_scc1 L_spinout_13
    s_branch L_spin_12
L_spinout_13:
L_rdy_11:
    buffer_store_dword v47, v46, s[32:35], s5 offen sc1
L_sig_10:
    s_mov_b64 exec, -1
L_sk4_9:
    v_mul_f32 v27, s8, v20
    v_fma_f32 v28, v20, s8, -v27
    v_fmac_f32 v28, s9, v20
    v_exp_f32 v27, v27
    v_mul_f32 v28, s10, v28
    v_fma_f32 v20, v27, v28, v27
    v_cvt_pk_bf16_f32 v27, v20, v20
    v_lshlrev_b32 v20, 16, v27
    v_mul_f32 v27, s8, v26
    v_fma_f32 v28, v26, s8, -v27
    v_fmac_f32 v28, s9, v26
    v_exp_f32 v27, v27
    v_mul_f32 v28, s10, v28
    v_fma_f32 v26, v27, v28, v27
    v_cvt_pk_bf16_f32 v27, v26, v26
    v_lshlrev_b32 v26, 16, v27
    v_readlane_b32 s12, v24, 63
    s_lshr_b32 s12, s12, 7
    s_min_u32 s12, s12, 252
    s_sub_u32 s13, 253, s12
    s_lshl_b32 s13, s13, 23
    s_add_u32 s14, s12, 2
    s_lshl_b32 s14, s14, 23
    v_mul_f32 v20, v20, v26
    v_mul_f32 v21, v21, v26
    v_mul_f32 v20, s8, v20
    v_sub_f32 v20, 0, v20
    v_mul_f32 v21, s11, v21
    v_mul_f32 v22, s13, v22
    v_mul_f32 v23, s13, v23
    v_mul_f32 v26, s14, v26
    s_lshl_b32 s15, s56, 2
    s_add_u32 s15, s15, 121648
    v_mov_b32 v27, s15
    s_mov_b64 exec, 1
    ds_write_b32 v27, v26
    s_mov_b64 exec, -1
    s_mul_i32 s15, s56, 31008
    s_and_b32 s16, s20, 1
    s_lshl_b32 s16, s16, 8
    s_add_u32 s15, s15, s16
    v_add_u32 v27, s15, v4
    v_mul_f32 v28, 0x3f800000, v20
    v_mul_f32 v29, 0x3f800000, v21
    v_exp_f32 v28, v28
    v_fract_f32 v29, v29
    v_cos_f32 v32, v29
    v_sin_f32 v33, v29
    s_nop 0
    v_mul_f32 v32, v32, v28
    v_mul_f32 v33, v33, v28
    v_mul_f32 v28, 0x43000000, v20
    v_mul_f32 v29, 0x43000000, v21
    v_exp_f32 v28, v28
    v_fract_f32 v29, v29
    v_cos_f32 v50, v29
    v_sin_f32 v51, v29
    s_nop 0
    v_mul_f32 v50, v50, v28
    v_mul_f32 v51, v51, v28
    v_mul_f32 v28, 0x41000000, v20
    v_mul_f32 v29, 0x41000000, v21
    v_exp_f32 v28, v28
    v_fract_f32 v29, v29
    v_cos_f32 v52, v29
    v_sin_f32 v53, v29
    s_nop 0
    v_mul_f32 v52, v52, v28
    v_mul_f32 v53, v53, v28
    v_pk_mul_f32 v[28:29], v[32:33], v[32:33] op_sel:[1,1] op_sel_hi:[1,0]
    v_pk_fma_f32 v[34:35], v[32:33], v[32:33], v[28:29] op_sel:[0,0,0] op_sel_hi:[0,1,1] neg_lo:[0,0,1]
    v_pk_mul_f32 v[28:29], v[34:35], v[32:33] op_sel:[1,1] op_sel_hi:[1,0]
    v_pk_fma_f32 v[36:37], v[34:35], v[32:33], v[28:29] op_sel:[0,0,0] op_sel_hi:[0,1,1] neg_lo:[0,0,1]
    v_pk_mul_f32 v[28:29], v[34:35], v[34:35] op_sel:[1,1] op_sel_hi:[1,0]
    v_pk_fma_f32 v[38:39], v[34:35], v[34:35], v[28:29] op_sel:[0,0,0] op_sel_hi:[0,1,1] neg_lo:[0,0,1]
    v_pk_mul_f32 v[28:29], v[38:39], v[32:33] op_sel:[1,1] op_sel_hi:[1,0]
    v_pk_fma_f32 v[40:41], v[38:39], v[32:33], v[28:29] op_sel:[0,0,0] op_sel_hi:[0,1,1] neg_lo:[0,0,1]
    v_pk_mul_f32 v[28:29], v[38:39], v[34:35] op_sel:[1,1] op_sel_hi:[1,0]
    v_pk_fma_f32 v[42:43], v[38:39], v[34:35], v[28:29] op_sel:[0,0,0] op_sel_hi:[0,1,1] neg_lo:[0,0,1]
    v_pk_mul_f32 v[28:29], v[38:39], v[36:37] op_sel:[1,1] op_sel_hi:[1,0]
    v_pk_fma_f32 v[44:45], v[38:39], v[36:37], v[28:29] op_sel:[0,0,0] op_sel_hi:[0,1,1] neg_lo:[0,0,1]
    v_mov_b32 v62, 0x00003c00
    ds_write_b32 v27, v62 offset:22304
    v_cvt_pk_f16_f32 v76, v52, v53
    ds_write_b32 v27, v76 offset:22848
    v_pk_mul_f32 v[28:29], v[52:53], v[52:53] op_sel:[1,1] op_sel_hi:[1,0]
    v_pk_fma_f32 v[58:59], v[52:53], v[52:53], v[28:29] op_sel:[0,0,0] op_sel_hi:[0,1,1] neg_lo:[0,0,1]
    v_cvt_pk_f16_f32 v77, v58, v59
    ds_write_b32 v27, v77 offset:23392
    v_pk_mul_f32 v[28:29], v[58:59], v[52:53] op_sel:[1,1] op_sel_hi:[1,0]
    v_pk_fma_f32 v[60:61], v[58:59], v[52:53], v[28:29] op_sel:[0,0,0] op_sel_hi:[0,1,1] neg_lo:[0,0,1]
    v_cvt_pk_f16_f32 v78, v60, v61
    ds_write_b32 v27, v78 offset:23936
    v_pk_mul_f32 v[28:29], v[60:61], v[52:53] op_sel:[1,1] op_sel_hi:[1,0]
    v_pk_fma_f32 v[58:59], v[60:61], v[52:53], v[28:29] op_sel:[0,0,0] op_sel_hi:[0,1,1] neg_lo:[0,0,1]
    v_cvt_pk_f16_f32 v79, v58, v59
    ds_write_b32 v27, v79 offset:24480
    v_pk_mul_f32 v[28:29], v[58:59], v[52:53] op_sel:[1,1] op_sel_hi:[1,0]
    v_pk_fma_f32 v[60:61], v[58:59], v[52:53], v[28:29] op_sel:[0,0,0] op_sel_hi:[0,1,1] neg_lo:[0,0,1]
    v_cvt_pk_f16_f32 v80, v60, v61
    ds_write_b32 v27, v80 offset:25024
    v_pk_mul_f32 v[28:29], v[60:61], v[52:53] op_sel:[1,1] op_sel_hi:[1,0]
    v_pk_fma_f32 v[58:59], v[60:61], v[52:53], v[28:29] op_sel:[0,0,0] op_sel_hi:[0,1,1] neg_lo:[0,0,1]
    v_cvt_pk_f16_f32 v81, v58, v59
    ds_write_b32 v27, v81 offset:25568
    v_pk_mul_f32 v[28:29], v[58:59], v[52:53] op_sel:[1,1] op_sel_hi:[1,0]
    v_pk_fma_f32 v[60:61], v[58:59], v[52:53], v[28:29] op_sel:[0,0,0] op_sel_hi:[0,1,1] neg_lo:[0,0,1]
    v_cvt_pk_f16_f32 v82, v60, v61
    ds_write_b32 v27, v82 offset:26112
    v_pk_mul_f32 v[28:29], v[60:61], v[52:53] op_sel:[1,1] op_sel_hi:[1,0]
    v_pk_fma_f32 v[58:59], v[60:61], v[52:53], v[28:29] op_sel:[0,0,0] op_sel_hi:[0,1,1] neg_lo:[0,0,1]
    v_cvt_pk_f16_f32 v83, v58, v59
    ds_write_b32 v27, v83 offset:26656
    v_pk_mul_f32 v[28:29], v[58:59], v[52:53] op_sel:[1,1] op_sel_hi:[1,0]
    v_pk_fma_f32 v[60:61], v[58:59], v[52:53], v[28:29] op_sel:[0,0,0] op_sel_hi:[0,1,1] neg_lo:[0,0,1]
    v_cvt_pk_f16_f32 v76, v60, v61
    ds_write_b32 v27, v76 offset:27200
    v_pk_mul_f32 v[28:29], v[60:61], v[52:53] op_sel:[1,1] op_sel_hi:[1,0]
    v_pk_fma_f32 v[58:59], v[60:61], v[52:53], v[28:29] op_sel:[0,0,0] op_sel_hi:[0,1,1] neg_lo:[0,0,1]
    v_cvt_pk_f16_f32 v77, v58, v59
    ds_write_b32 v27, v77 offset:27744
    v_pk_mul_f32 v[28:29], v[58:59], v[52:53] op_sel:[1,1] op_sel_hi:[1,0]
    v_pk_fma_f32 v[60:61], v[58:59], v[52:53], v[28:29] op_sel:[0,0,0] op_sel_hi:[0,1,1] neg_lo:[0,0,1]
    v_cvt_pk_f16_f32 v78, v60, v61
    ds_write_b32 v27, v78 offset:28288
    v_pk_mul_f32 v[28:29], v[60:61], v[52:53] op_sel:[1,1] op_sel_hi:[1,0]
    v_pk_fma_f32 v[58:59], v[60:61], v[52:53], v[28:29] op_sel:[0,0,0] op_sel_hi:[0,1,1] neg_lo:[0,0,1]
    v_cvt_pk_f16_f32 v79, v58, v59
    ds_write_b32 v27, v79 offset:28832
    v_pk_mul_f32 v[28:29], v[58:59], v[52:53] op_sel:[1,1] op_sel_hi:[1,0]
    v_pk_fma_f32 v[60:61], v[58:59], v[52:53], v[28:29] op_sel:[0,0,0] op_sel_hi:[0,1,1] neg_lo:[0,0,1]
    v_cvt_pk_f16_f32 v80, v60, v61
    ds_write_b32 v27, v80 offset:29376
    v_pk_mul_f32 v[28:29], v[60:61], v[52:53] op_sel:[1,1] op_sel_hi:[1,0]
    v_pk_fma_f32 v[58:59], v[60:61], v[52:53], v[28:29] op_sel:[0,0,0] op_sel_hi:[0,1,1] neg_lo:[0,0,1]
    v_cvt_pk_f16_f32 v81, v58, v59
    ds_write_b32 v27, v81 offset:29920
    v_pk_mul_f32 v[28:29], v[58:59], v[52:53] op_sel:[1,1] op_sel_hi:[1,0]
    v_pk_fma_f32 v[60:61], v[58:59], v[52:53], v[28:29] op_sel:[0,0,0] op_sel_hi:[0,1,1] neg_lo:[0,0,1]
    v_cvt_pk_f16_f32 v82, v60, v61
    ds_write_b32 v27, v82 offset:30464
    v_cvt_pk_f16_f32 v83, v22, -v23
    ds_write_b32 v27, v83 offset:0
    v_pk_mul_f32 v[28:29], v[22:23], v[32:33] op_sel:[1,1] op_sel_hi:[1,0]
    v_pk_fma_f32 v[58:59], v[22:23], v[32:33], v[28:29] op_sel:[0,0,0] op_sel_hi:[0,1,1] neg_lo:[0,0,1]
    v_cvt_pk_f16_f32 v76, v58, -v59
    ds_write_b32 v27, v76 offset:544
    v_pk_mul_f32 v[28:29], v[22:23], v[34:35] op_sel:[1,1] op_sel_hi:[1,0]
    v_pk_fma_f32 v[60:61], v[22:23], v[34:35], v[28:29] op_sel:[0,0,0] op_sel_hi:[0,1,1] neg_lo:[0,0,1]
    v_cvt_pk_f16_f32 v77, v60, -v61
    ds_write_b32 v27, v77 offset:1088
    v_pk_mul_f32 v[28:29], v[22:23], v[36:37] op_sel:[1,1] op_sel_hi:[1,0]
    v_pk_fma_f32 v[62:63], v[22:23], v[36:37], v[28:29] op_sel:[0,0,0] op_sel_hi:[0,1,1] neg_lo:[0,0,1]
    v_cvt_pk_f16_f32 v78, v62, -v63
    ds_write_b32 v27, v78 offset:1632
    v_pk_mul_f32 v[28:29], v[22:23], v[38:39] op_sel:[1,1] op_sel_hi:[1,0]
    v_pk_fma_f32 v[64:65], v[22:23], v[38:39], v[28:29] op_sel:[0,0,0] op_sel_hi:[0,1,1] neg_lo:[0,0,1]
    v_cvt_pk_f16_f32 v79, v64, -v65
    ds_write_b32 v27, v79 offset:2176
    v_pk_mul_f32 v[28:29], v[22:23], v[40:41] op_sel:[1,1] op_sel_hi:[1,0]
    v_pk_fma_f32 v[58:59], v[22:23], v[40:41], v[28:29] op_sel:[0,0,0] op_sel_hi:[0,1,1] neg_lo:[0,0,1]
    v_cvt_pk_f16_f32 v80, v58, -v59
    ds_write_b32 v27, v80 offset:2720
    v_pk_mul_f32 v[28:29], v[22:23], v[42:43] op_sel:[1,1] op_sel_hi:[1,0]
    v_pk_fma_f32 v[60:61], v[22:23], v[42:43], v[28:29] op_sel:[0,0,0] op_sel_hi:[0,1,1] neg_lo:[0,0,1]
    v_cvt_pk_f16_f32 v81, v60, -v61
    ds_write_b32 v27, v81 offset:3264
    v_pk_mul_f32 v[28:29], v[22:23], v[44:45] op_sel:[1,1] op_sel_hi:[1,0]
    v_pk_fma_f32 v[62:63], v[22:23], v[44:45], v[28:29] op_sel:[0,0,0] op_sel_hi:[0,1,1] neg_lo:[0,0,1]
    v_cvt_pk_f16_f32 v82, v62, -v63
    ds_write_b32 v27, v82 offset:3808
    v_pk_mul_f32 v[28:29], v[22:23], v[50:51] op_sel:[1,1] op_sel_hi:[1,0]
    v_pk_fma_f32 v[54:55], v[22:23], v[50:51], v[28:29] op_sel:[0,0,0] op_sel_hi:[0,1,1] neg_lo:[0,0,1]
    v_cvt_pk_f16_f32 v83, v54, -v55
    ds_write_b32 v27, v83 offset:4352
    v_pk_mul_f32 v[28:29], v[54:55], v[32:33] op_sel:[1,1] op_sel_hi:[1,0]
    v_pk_fma_f32 v[64:65], v[54:55], v[32:33], v[28:29] op_sel:[0,0,0] op_sel_hi:[0,1,1] neg_lo:[0,0,1]
    v_cvt_pk_f16_f32 v76, v64, -v65
    ds_write_b32 v27, v76 offset:4896
    v_pk_mul_f32 v[28:29], v[54:55], v[34:35] op_sel:[1,1] op_sel_hi:[1,0]
    v_pk_fma_f32 v[58:59], v[54:55], v[34:35], v[28:29] op_sel:[0,0,0] op_sel_hi:[0,1,1] neg_lo:[0,0,1]
    v_cvt_pk_f16_f32 v77, v58, -v59
    ds_write_b32 v27, v77 offset:5440
    v_pk_mul_f32 v[28:29], v[54:55], v[36:37] op_sel:[1,1] op_sel_hi:[1,0]
    v_pk_fma_f32 v[60:61], v[54:55], v[36:37], v[28:29] op_sel:[0,0,0] op_sel_hi:[0,1,1] neg_lo:[0,0,1]
    v_cvt_pk_f16_f32 v78, v60, -v61
    ds_write_b32 v27, v78 offset:5984
    v_pk_mul_f32 v[28:29], v[54:55], v[38:39] op_sel:[1,1] op_sel_hi:[1,0]
    v_pk_fma_f32 v[62:63], v[54:55], v[38:39], v[28:29] op_sel:[0,0,0] op_sel_hi:[0,1,1] neg_lo:[0,0,1]
    v_cvt_pk_f16_f32 v79, v62, -v63
    ds_write_b32 v27, v79 offset:6528
    v_pk_mul_f32 v[28:29], v[54:55], v[40:41] op_sel:[1,1] op_sel_hi:[1,0]
    v_pk_fma_f32 v[64:65], v[54:55], v[40:41], v[28:29] op_sel:[0,0,0] op_sel_hi:[0,1,1] neg_lo:[0,0,1]
    v_cvt_pk_f16_f32 v80, v64, -v65
    ds_write_b32 v27, v80 offset:7072
    v_pk_mul_f32 v[28:29], v[54:55], v[42:43] op_sel:[1,1] op_sel_hi:[1,0]
    v_pk_fma_f32 v[58:59], v[54:55], v[42:43], v[28:29] op_sel:[0,0,0] op_sel_hi:[0,1,1] neg_lo:[0,0,1]
    v_cvt_pk_f16_f32 v81, v58, -v59
    ds_write_b32 v27, v81 offset:7616
    v_pk_mul_f32 v[28:29], v[54:55], v[44:45] op_sel:[1,1] op_sel_hi:[1,0]
    v_pk_fma_f32 v[60:61], v[54:55], v[44:45], v[28:29] op_sel:[0,0,0] op_sel_hi:[0,1,1] neg_lo:[0,0,1]
    v_cvt_pk_f16_f32 v82, v60, -v61
    ds_write_b32 v27, v82 offset:8160
    v_pk_mul_f32 v[28:29], v[54:55], v[50:51] op_sel:[1,1] op_sel_hi:[1,0]
    v_pk_fma_f32 v[56:57], v[54:55], v[50:51], v[28:29] op_sel:[0,0,0] op_sel_hi:[0,1,1] neg_lo:[0,0,1]
    v_cvt_pk_f16_f32 v83, v56, -v57
    ds_write_b32 v27, v83 offset:8704
    v_pk_mul_f32 v[28:29], v[56:57], v[34:35] op_sel:[1,1] op_sel_hi:[1,0]
    v_pk_fma_f32 v[62:63], v[56:57], v[34:35], v[28:29] op_sel:[0,0,0] op_sel_hi:[0,1,1] neg_lo:[0,0,1]
    v_cvt_pk_f16_f32 v76, v62, -v63
    ds_write_b32 v27, v76 offset:9248
    v_pk_mul_f32 v[28:29], v[56:57], v[38:39] op_sel:[1,1] op_sel_hi:[1,0]
    v_pk_fma_f32 v[64:65], v[56:57], v[38:39], v[28:29] op_sel:[0,0,0] op_sel_hi:[0,1,1] neg_lo:[0,0,1]
    v_cvt_pk_f16_f32 v77, v64, -v65
    ds_write_b32 v27, v77 offset:9792
    v_pk_mul_f32 v[28:29], v[56:57], v[42:43] op_sel:[1,1] op_sel_hi:[1,0]
    v_pk_fma_f32 v[58:59], v[56:57], v[42:43], v[28:29] op_sel:[0,0,0] op_sel_hi:[0,1,1] neg_lo:[0,0,1]
    v_cvt_pk_f16_f32 v78, v58, -v59
    ds_write_b32 v27, v78 offset:10336
    v_pk_mul_f32 v[28:29], v[56:57], v[50:51] op_sel:[1,1] op_sel_hi:[1,0]
    v_pk_fma_f32 v[54:55], v[56:57], v[50:51], v[28:29] op_sel:[0,0,0] op_sel_hi:[0,1,1] neg_lo:[0,0,1]
    s_cmp_ge_u32 s20, 4
    s_cbranch_scc1 L_sk_14
    s_waitcnt vmcnt(0)
    v_mov_b32 v46, 121632
    v_mov_b32 v47, 1
    s_mov_b64 exec, 1
    ds_add_rtn_u32 v48, v46, v47
    s_waitcnt lgkmcnt(0)
    v_readfirstlane_b32 s4, v48
    s_lshl_b32 s5, s2, 4
    s_add_u32 s5, s5, 5251072
    s_cmp_lg_u32 s4, 7
    s_cbranch_scc1 L_sig_15
    v_mov_b32 v46, 0
    v_cmp_ne_u32 vcc, 0, v49
    s_cbranch_vccnz L_rdy_16
    s_mov_b32 s4, 0
L_spin_17:
    buffer_load_dword v48, v46, s[24:27], 0 offen sc1
    s_waitcnt vmcnt(0)
    v_cmp_ne_u32 vcc, 0, v48
    s_add_u32 s4, s4, 1
    s_cmp_ge_u32 s4, 262144
    s_cbranch_scc1 L_spinout_18
    s_cmp_eq_u64 vcc, exec
    s_cbranch_scc1 L_spinout_18
    s_branch L_spin_17
L_spinout_18:
L_rdy_16:
    buffer_store_dword v47, v46, s[32:35], s5 offen sc1
L_sig_15:
    s_mov_b64 exec, -1
L_sk_14:
    v_cvt_pk_f16_f32 v79, v54, -v55
    ds_write_b32 v27, v79 offset:10880
    v_pk_mul_f32 v[28:29], v[54:55], v[34:35] op_sel:[1,1] op_sel_hi:[1,0]
    v_pk_fma_f32 v[60:61], v[54:55], v[34:35], v[28:29] op_sel:[0,0,0] op_sel_hi:[0,1,1] neg_lo:[0,0,1]
    v_cvt_pk_f16_f32 v80, v60, -v61
    ds_write_b32 v27, v80 offset:11424
    v_pk_mul_f32 v[28:29], v[54:55], v[38:39] op_sel:[1,1] op_sel_hi:[1,0]
    v_pk_fma_f32 v[62:63], v[54:55], v[38:39], v[28:29] op_sel:[0,0,0] op_sel_hi:[0,1,1] neg_lo:[0,0,1]
    v_cvt_pk_f16_f32 v81, v62, -v63
    ds_write_b32 v27, v81 offset:11968
    v_pk_mul_f32 v[28:29], v[54:55], v[42:43] op_sel:[1,1] op_sel_hi:[1,0]
    v_pk_fma_f32 v[64:65], v[54:55], v[42:43], v[28:29] op_sel:[0,0,0] op_sel_hi:[0,1,1] neg_lo:[0,0,1]
    v_cvt_pk_f16_f32 v82, v64, -v65
    ds_write_b32 v27, v82 offset:12512
    v_pk_mul_f32 v[28:29], v[54:55], v[50:51] op_sel:[1,1] op_sel_hi:[1,0]
    v_pk_fma_f32 v[56:57], v[54:55], v[50:51], v[28:29] op_sel:[0,0,0] op_sel_hi:[0,1,1] neg_lo:[0,0,1]
    v_cvt_pk_f16_f32 v83, v56, -v57
    ds_write_b32 v27, v83 offset:13056
    v_pk_mul_f32 v[28:29], v[56:57], v[38:39] op_sel:[1,1] op_sel_hi:[1,0]
    v_pk_fma_f32 v[58:59], v[56:57], v[38:39], v[28:29] op_sel:[0,0,0] op_sel_hi:[0,1,1] neg_lo:[0,0,1]
    v_cvt_pk_f16_f32 v76, v58, -v59
    ds_write_b32 v27, v76 offset:13600
    v_pk_mul_f32 v[28:29], v[56:57], v[50:51] op_sel:[1,1] op_sel_hi:[1,0]
    v_pk_fma_f32 v[54:55], v[56:57], v[50:51], v[28:29] op_sel:[0,0,0] op_sel_hi:[0,1,1] neg_lo:[0,0,1]
    v_cvt_pk_f16_f32 v77, v54, -v55
    ds_write_b32 v27, v77 offset:14144
    v_pk_mul_f32 v[28:29], v[54:55], v[38:39] op_sel:[1,1] op_sel_hi:[1,0]
    v_pk_fma_f32 v[60:61], v[54:55], v[38:39], v[28:29] op_sel:[0,0,0] op_sel_hi:[0,1,1] neg_lo:[0,0,1]
    v_cvt_pk_f16_f32 v78, v60, -v61
    ds_write_b32 v27, v78 offset:14688
    v_pk_mul_f32 v[28:29], v[54:55], v[50:51] op_sel:[1,1] op_sel_hi:[1,0]
    v_pk_fma_f32 v[56:57], v[54:55], v[50:51], v[28:29] op_sel:[0,0,0] op_sel_hi:[0,1,1] neg_lo:[0,0,1]
    v_cvt_pk_f16_f32 v79, v56, -v57
    ds_write_b32 v27, v79 offset:15232
    v_pk_mul_f32 v[28:29], v[56:57], v[38:39] op_sel:[1,1] op_sel_hi:[1,0]
    v_pk_fma_f32 v[62:63], v[56:57], v[38:39], v[28:29] op_sel:[0,0,0] op_sel_hi:[0,1,1] neg_lo:[0,0,1]
    v_cvt_pk_f16_f32 v80, v62, -v63
    ds_write_b32 v27, v80 offset:15776
    v_pk_mul_f32 v[28:29], v[56:57], v[50:51] op_sel:[1,1] op_sel_hi:[1,0]
    v_pk_fma_f32 v[54:55], v[56:57], v[50:51], v[28:29] op_sel:[0,0,0] op_sel_hi:[0,1,1] neg_lo:[0,0,1]
    v_cvt_pk_f16_f32 v81, v54, -v55
    ds_write_b32 v27, v81 offset:16320
    v_pk_mul_f32 v[28:29], v[54:55], v[38:39] op_sel:[1,1] op_sel_hi:[1,0]
    v_pk_fma_f32 v[64:65], v[54:55], v[38:39], v[28:29] op_sel:[0,0,0] op_sel_hi:[0,1,1] neg_lo:[0,0,1]
    v_cvt_pk_f16_f32 v82, v64, -v65
    ds_write_b32 v27, v82 offset:16864
    v_pk_mul_f32 v[28:29], v[54:55], v[50:51] op_sel:[1,1] op_sel_hi:[1,0]
    v_pk_fma_f32 v[56:57], v[54:55], v[50:51], v[28:29] op_sel:[0,0,0] op_sel_hi:[0,1,1] neg_lo:[0,0,1]
    v_cvt_pk_f16_f32 v83, v56, -v57
    ds_write_b32 v27, v83 offset:17408
    v_pk_mul_f32 v[28:29], v[56:57], v[50:51] op_sel:[1,1] op_sel_hi:[1,0]
    v_pk_fma_f32 v[54:55], v[56:57], v[50:51], v[28:29] op_sel:[0,0,0] op_sel_hi:[0,1,1] neg_lo:[0,0,1]
    v_cvt_pk_f16_f32 v76, v54, -v55
    ds_write_b32 v27, v76 offset:17952
    v_pk_mul_f32 v[28:29], v[54:55], v[50:51] op_sel:[1,1] op_sel_hi:[1,0]
    v_pk_fma_f32 v[56:57], v[54:55], v[50:51], v[28:29] op_sel:[0,0,0] op_sel_hi:[0,1,1] neg_lo:[0,0,1]
    v_cvt_pk_f16_f32 v77, v56, -v57
    ds_write_b32 v27, v77 offset:18496
    v_pk_mul_f32 v[28:29], v[56:57], v[50:51] op_sel:[1,1] op_sel_hi:[1,0]
    v_pk_fma_f32 v[54:55], v[56:57], v[50:51], v[28:29] op_sel:[0,0,0] op_sel_hi:[0,1,1] neg_lo:[0,0,1]
    v_cvt_pk_f16_f32 v78, v54, -v55
    ds_write_b32 v27, v78 offset:19040
    v_pk_mul_f32 v[28:29], v[54:55], v[50:51] op_sel:[1,1] op_sel_hi:[1,0]
    v_pk_fma_f32 v[56:57], v[54:55], v[50:51], v[28:29] op_sel:[0,0,0] op_sel_hi:[0,1,1] neg_lo:[0,0,1]
    v_cvt_pk_f16_f32 v79, v56, -v57
    ds_write_b32 v27, v79 offset:19584
    v_pk_mul_f32 v[28:29], v[56:57], v[50:51] op_sel:[1,1] op_sel_hi:[1,0]
    v_pk_fma_f32 v[54:55], v[56:57], v[50:51], v[28:29] op_sel:[0,0,0] op_sel_hi:[0,1,1] neg_lo:[0,0,1]
    v_cvt_pk_f16_f32 v80, v54, -v55
    ds_write_b32 v27, v80 offset:20128
    v_pk_mul_f32 v[28:29], v[54:55], v[50:51] op_sel:[1,1] op_sel_hi:[1,0]
    v_pk_fma_f32 v[56:57], v[54:55], v[50:51], v[28:29] op_sel:[0,0,0] op_sel_hi:[0,1,1] neg_lo:[0,0,1]
    v_cvt_pk_f16_f32 v81, v56, -v57
    ds_write_b32 v27, v81 offset:20672
    v_pk_mul_f32 v[28:29], v[56:57], v[50:51] op_sel:[1,1] op_sel_hi:[1,0]
    v_pk_fma_f32 v[54:55], v[56:57], v[50:51], v[28:29] op_sel:[0,0,0] op_sel_hi:[0,1,1] neg_lo:[0,0,1]
    v_cvt_pk_f16_f32 v82, v54, -v55
    ds_write_b32 v27, v82 offset:21216
    v_pk_mul_f32 v[28:29], v[54:55], v[50:51] op_sel:[1,1] op_sel_hi:[1,0]
    v_pk_fma_f32 v[56:57], v[54:55], v[50:51], v[28:29] op_sel:[0,0,0] op_sel_hi:[0,1,1] neg_lo:[0,0,1]
    v_cvt_pk_f16_f32 v83, v56, -v57
    ds_write_b32 v27, v83 offset:21760
    s_lshl_b32 s4, s56, 2
    s_add_u32 s4, s4, 121728
    v_mov_b32 v46, s4
    v_mov_b32 v47, 1
    s_waitcnt lgkmcnt(0)
    s_mov_b64 exec, 1
    ds_add_u32 v46, v47
    s_mov_b32 s4, 0
L_spin_19:
    ds_read_b32 v48, v46
    s_waitcnt lgkmcnt(0)
    v_cmp_le_u32 vcc, 2, v48
    s_add_u32 s4, s4, 1
    s_cmp_ge_u32 s4, 262144
    s_cbranch_scc1 L_spinout_20
    s_cmp_eq_u64 vcc, exec
    s_cbranch_scc1 L_spinout_20
    s_branch L_spin_19
L_spinout_20:
    s_mov_b64 exec, -1
    s_and_b32 s30, s20, 1
    s_branch L_kmfma_7
L_pf_8:
    s_waitcnt vmcnt(0)
    v_mov_b32 v46, 121632
    v_mov_b32 v47, 1
    s_mov_b64 exec, 1
    ds_add_rtn_u32 v48, v46, v47
    s_waitcnt lgkmcnt(0)
    v_readfirstlane_b32 s4, v48
    s_lshl_b32 s5, s2, 4
    s_add_u32 s5, s5, 5251072
    s_cmp_lg_u32 s4, 7
    s_cbranch_scc1 L_sig_21
    v_mov_b32 v46, 0
    v_cmp_ne_u32 vcc, 0, v49
    s_cbranch_vccnz L_rdy_22
    s_mov_b32 s4, 0
L_spin_23:
    buffer_load_dword v48, v46, s[24:27], 0 offen sc1
    s_waitcnt vmcnt(0)
    v_cmp_ne_u32 vcc, 0, v48
    s_add_u32 s4, s4, 1
    s_cmp_ge_u32 s4, 262144
    s_cbranch_scc1 L_spinout_24
    s_cmp_eq_u64 vcc, exec
    s_cbranch_scc1 L_spinout_24
    s_branch L_spin_23
L_spinout_24:
L_rdy_22:
    buffer_store_dword v47, v46, s[32:35], s5 offen sc1
L_sig_21:
    s_mov_b64 exec, -1
    v_readfirstlane_b32 s101, v49
    s_cmp_lg_u32 s2, 0
    s_cbranch_scc1 L_notmaster_25
    s_cmp_lg_u32 s20, 7
    s_cbranch_scc1 L_notmaster_25
    s_mov_b32 s5, 5251072
    s_mov_b32 s6, 5253120
    s_mov_b32 s4, 0
L_gf_26:
    buffer_load_dword v44, v3, s[32:35], s5 offen sc1
    buffer_load_dword v45, v3, s[32:35], s5 offen offset:1024 sc1
    buffer_load_dword v46, v3, s[32:35], s6 offen sc1
    buffer_load_dword v47, v3, s[32:35], s6 offen offset:1024 sc1
    s_add_u32 s4, s4, 1
    s_waitcnt vmcnt(0)
    v_min_u32 v48, v44, v45
    v_min3_u32 v48, v48, v46, v47
    v_cmp_eq_u32 vcc, 0, v48
    s_cmp_ge_u32 s4, 262144
    s_cbranch_scc1 L_gfo_27
    s_and_b64 exec, exec, vcc
    s_cbranch_execnz L_gf_26
L_gfo_27:
    s_mov_b64 exec, -1
    v_mov_b32 v47, 1
    v_lshlrev_b32 v46, 12, v2
    s_mov_b32 s5, 5275904
    s_mov_b64 exec, 0xff
    buffer_store_dword v47, v46, s[32:35], s5 offen sc1
    s_mov_b64 exec, -1
L_notmaster_25:
    s_sub_u32 s5, s20, 6
L_t67_29:
    s_lshl_b32 s4, s5, 2
    s_add_u32 s4, s4, 121728
    v_mov_b32 v46, s4
    s_mov_b32 s7, s5
    s_mov_b64 exec, 1
    s_mov_b32 s4, 0
L_spin_30:
    ds_read_b32 v48, v46
    s_waitcnt lgkmcnt(0)
    v_cmp_le_u32 vcc, 2, v48
    s_add_u32 s4, s4, 1
    s_cmp_ge_u32 s4, 262144
    s_cbranch_scc1 L_spinout_31
    s_cmp_eq_u64 vcc, exec
    s_cbranch_scc1 L_spinout_31
    s_sleep 1
    s_branch L_spin_30
L_spinout_31:
    s_mov_b64 exec, -1
    s_mov_b32 s56, s7
    s_mov_b32 s30, 2
L_kmfma_7:
    v_and_b32 v44, 15, v2
    v_lshrrev_b32 v45, 4, v2
    v_mul_u32_u24 v46, 544, v44
    v_lshl_add_u32 v46, v45, 4, v46
    s_mov_b32 s4, s30
    s_mov_b32 s5, s56
L_task_32:
    s_mov_b32 s6, s4
    s_mul_i32 s8, s5, 31008
    s_mul_i32 s9, s6, 8704
    s_add_u32 s9, s9, s8
    s_add_u32 s8, s8, 22304
    v_add_u32 v47, s9, v46
    v_add_u32 v48, s8, v46
    ds_read_b128 v[64:67], v47 offset:0
    ds_read_b128 v[68:71], v48 offset:0
    ds_read_b128 v[72:75], v47 offset:64
    ds_read_b128 v[76:79], v48 offset:64
    ds_read_b128 v[80:83], v47 offset:128
    ds_read_b128 v[84:87], v48 offset:128
    ds_read_b128 v[88:91], v47 offset:192
    ds_read_b128 v[92:95], v48 offset:192
    ds_read_b128 v[96:99], v47 offset:256
    ds_read_b128 v[100:103], v48 offset:256
    ds_read_b128 v[104:107], v47 offset:320
    ds_read_b128 v[108:111], v48 offset:320
    ds_read_b128 v[112:115], v47 offset:384
    ds_read_b128 v[116:119], v48 offset:384
    ds_read_b128 v[120:123], v47 offset:448
    ds_read_b128 v[124:127], v48 offset:448
    s_mul_i32 s8, s5, 1344
    s_add_u32 s8, s8, 103792
    s_cmp_eq_u32 s6, 2
    s_cbranch_scc1 L_t2_33
    s_waitcnt lgkmcnt(14)
    v_mfma_f32_16x16x32_f16 v[56:59], v[64:67], v[68:71], 0
    s_waitcnt lgkmcnt(12)
    v_mfma_f32_16x16x32_f16 v[56:59], v[72:75], v[76:79], v[56:59]
    s_waitcnt lgkmcnt(10)
    v_mfma_f32_16x16x32_f16 v[56:59], v[80:83], v[84:87], v[56:59]
    s_waitcnt lgkmcnt(8)
    v_mfma_f32_16x16x32_f16 v[56:59], v[88:91], v[92:95], v[56:59]
    s_waitcnt lgkmcnt(6)
    v_mfma_f32_16x16x32_f16 v[56:59], v[96:99], v[100:103], v[56:59]
    s_waitcnt lgkmcnt(4)
    v_mfma_f32_16x16x32_f16 v[56:59], v[104:107], v[108:111], v[56:59]
    s_waitcnt lgkmcnt(2)
    v_mfma_f32_16x16x32_f16 v[56:59], v[112:115], v[116:119], v[56:59]
    s_waitcnt lgkmcnt(0)
    v_mfma_f32_16x16x32_f16 v[56:59], v[120:123], v[124:127], v[56:59]
    s_cmp_eq_u32 s6, 1
    s_cbranch_scc1 L_t1_34
    v_lshrrev_b32 v49, 1, v45
    v_lshlrev_b32 v49, 8, v49
    v_lshl_add_u32 v49, v44, 4, v49
    v_and_b32 v50, 1, v45
    v_lshl_add_u32 v49, v50, 3, v49
    v_add_u32 v49, s8, v49
    s_nop 4
    v_cvt_pk_f16_f32 v60, v56, v57
    v_cvt_pk_f16_f32 v61, v58, v59
    ds_write_b64 v49, v[60:61]
    s_branch L_next_35
L_t1_34:
    v_lshlrev_b32 v49, 7, v45
    v_add_u32 v49, s8, v49
    v_lshl_add_u32 v50, v44, 3, v49
    v_add_u32 v50, 512, v50
    v_add_u32 v51, 4, v50
    v_lshl_add_u32 v52, v44, 2, v49
    v_add_u32 v52, 512, v52
    v_add_u32 v53, 64, v52
    v_cmp_gt_u32 vcc, 2, v45
    s_nop 1
    v_cndmask_b32 v50, v52, v50, vcc
    v_cndmask_b32 v51, v53, v51, vcc
    v_cvt_pk_f16_f32 v60, v56, v57
    v_cvt_pk_f16_f32 v61, v58, v59
    ds_write_b32 v50, v60
    ds_write_b32 v51, v61
    s_branch L_next_35
L_t2_33:
    s_waitcnt lgkmcnt(14)
    v_mfma_f32_16x16x32_f16 v[56:59], v[68:71], v[64:67], 0
    s_waitcnt lgkmcnt(12)
    v_mfma_f32_16x16x32_f16 v[56:59], v[76:79], v[72:75], v[56:59]
    s_waitcnt lgkmcnt(10)
    v_mfma_f32_16x16x32_f16 v[56:59], v[84:87], v[80:83], v[56:59]
    s_waitcnt lgkmcnt(8)
    v_mfma_f32_16x16x32_f16 v[56:59], v[92:95], v[88:91], v[56:59]
    s_waitcnt lgkmcnt(6)
    v_mfma_f32_16x16x32_f16 v[56:59], v[100:103], v[96:99], v[56:59]
    s_waitcnt lgkmcnt(4)
    v_mfma_f32_16x16x32_f16 v[56:59], v[108:111], v[104:107], v[56:59]
    s_waitcnt lgkmcnt(2)
    v_mfma_f32_16x16x32_f16 v[56:59], v[116:119], v[112:115], v[56:59]
    s_waitcnt lgkmcnt(0)
    v_mfma_f32_16x16x32_f16 v[56:59], v[124:127], v[120:123], v[56:59]
    v_lshlrev_b32 v49, 5, v44
    v_lshl_add_u32 v49, v45, 3, v49
    v_add_u32 v49, 1024, v49
    v_add_u32 v49, s8, v49
    v_cmp_gt_u32 vcc, 9, v44
    s_nop 4
    v_cvt_pk_f16_f32 v60, v56, v57
    v_cvt_pk_f16_f32 v61, v58, v59
    s_and_saveexec_b64 s[10:11], vcc
    ds_write_b64 v49, v[60:61]
    s_mov_b64 exec, s[10:11]
L_next_35:
    s_cmp_lg_u32 s20, 6
    s_cbranch_scc1 L_kdone_28
    s_cmp_lg_u32 s5, 0
    s_cbranch_scc1 L_kdone_28
    s_mov_b32 s5, 2
    s_branch L_t67_29
L_kdone_28:
    s_mov_b32 s44, s70
    s_and_b32 s45, s71, 0xffff
    s_mov_b32 s46, 2211840
    s_mov_b32 s47, 0x00020000
    s_and_b32 s52, s2, 7
    s_mul_i32 s52, s52, 27
    s_lshr_b32 s53, s2, 3
    s_add_u32 s52, s52, s53
    s_and_b32 s54, s20, 1
    s_cmp_eq_u32 s54, 0
    s_cselect_b32 s40, s66, s68
    s_cselect_b32 s41, s67, s69
    s_and_b32 s41, s41, 0xffff
    s_mov_b32 s42, 2211840
    s_mov_b32 s43, 0x00020000
    s_bfe_u32 s54, s20, 0x10001
    s_mul_i32 s54, s54, 320
    s_mul_i32 s12, s54, 3456
    s_lshl_b32 s55, s52, 4
    s_add_u32 s12, s12, s55
    s_mul_i32 s17, s52, 10240
    s_lshl_b32 s55, s20, 8
    s_add_u32 s17, s17, s55
    s_cmp_lt_u32 s20, 5
    s_cselect_b32 s17, s17, 0x40000000
    s_cmp_lt_u32 s2, 216
    s_cselect_b32 s12, s12, 0x40000000
    s_cselect_b32 s17, s17, 0x40000000
    s_add_u32 s13, s12, 221184
    s_add_u32 s14, s12, 442368
    s_add_u32 s15, s12, 663552
    s_add_u32 s16, s12, 884736
    s_add_u32 s18, s17, 3840
    s_add_u32 s19, s17, 7680
    v_mul_u32_u24 v16, 3456, v2
    s_cmp_eq_u32 s20, 7
    s_cbranch_scc1 L_p0_37
    buffer_load_dword v188, v4, s[44:47], s17 offen offset:0
    buffer_load_dword v189, v4, s[44:47], s17 offen offset:1280
    buffer_load_dword v190, v4, s[44:47], s17 offen offset:2560
    buffer_load_dword v191, v4, s[44:47], s18 offen offset:0
    buffer_load_dword v192, v4, s[44:47], s18 offen offset:1280
    buffer_load_dword v193, v4, s[44:47], s18 offen offset:2560
    buffer_load_dword v194, v4, s[44:47], s19 offen offset:0
    buffer_load_dword v195, v4, s[44:47], s19 offen offset:1280
    s_branch L_p1_36
L_p0_37:
    v_mov_b32 v46, 0
    s_cmp_lg_u32 s101, 0
    s_cbranch_scc1 L_rdy2_38
    s_mov_b32 s4, 0
L_spin_39:
    buffer_load_dword v49, v46, s[24:27], 0 offen sc1
    s_waitcnt vmcnt(0)
    v_cmp_ne_u32 vcc, 0, v49
    s_add_u32 s4, s4, 1
    s_cmp_ge_u32 s4, 262144
    s_cbranch_scc1 L_spinout_40
    s_cmp_eq_u64 vcc, exec
    s_cbranch_scc1 L_spinout_40
    s_branch L_spin_39
L_spinout_40:
L_rdy2_38:
    s_and_b32 s5, s2, 7
    s_lshl_b32 s5, s5, 12
    s_add_u32 s5, s5, 5275904
    v_mov_b32 v46, 0
    s_mov_b32 s4, 0
L_spin_41:
    buffer_load_dword v47, v46, s[32:35], s5 offen sc1
    s_waitcnt vmcnt(0)
    v_cmp_ne_u32 vcc, 0, v47
    s_add_u32 s4, s4, 1
    s_cmp_ge_u32 s4, 262144
    s_cbranch_scc1 L_spinout_42
    s_cmp_eq_u64 vcc, exec
    s_cbranch_scc1 L_spinout_42
    s_branch L_spin_41
L_spinout_42:
L_p1_36:
    v_lshlrev_b32 v6, 3, v0
    v_mov_b32 v18, 0
    s_lshl_b32 s4, s61, 1
    s_add_u32 s4, s4, s60
    s_lshl_b32 s4, s4, 4
    s_add_u32 s4, s4, 0
    s_waitcnt lgkmcnt(0)
    s_barrier
    buffer_load_dwordx4 v[8:11], v160, s[32:35], s4 offen sc1
    buffer_load_dwordx4 v[12:15], v162, s[32:35], s4 offen sc1
    ds_read_u16 v32, v152 offset:0
    ds_read_u16 v33, v153 offset:0
    ds_read_u16 v34, v154 offset:0
    ds_read_u16 v35, v155 offset:0
    ds_read_u16 v36, v156 offset:0
    ds_read_u16 v37, v157 offset:0
    ds_read_u16 v38, v158 offset:0
    ds_read_u16 v48, v152 offset:1344
    ds_read_u16 v49, v153 offset:1344
    ds_read_u16 v50, v154 offset:1344
    ds_read_u16 v51, v155 offset:1344
    ds_read_u16 v52, v156 offset:1344
    ds_read_u16 v53, v157 offset:1344
    ds_read_u16 v54, v158 offset:1344
    ds_read_u16 v64, v152 offset:2688
    ds_read_u16 v65, v153 offset:2688
    ds_read_u16 v66, v154 offset:2688
    ds_read_u16 v67, v155 offset:2688
    ds_read_u16 v68, v156 offset:2688
    ds_read_u16 v69, v157 offset:2688
    ds_read_u16 v70, v158 offset:2688
    v_cmp_gt_u32 vcc, 96, v0
    s_and_saveexec_b64 s[4:5], vcc
    ds_write_b32 v164, v18
    s_mov_b64 exec, s[4:5]
    s_waitcnt lgkmcnt(14)
    v_lshl_or_b32 v40, v33, 16, v32
    v_lshl_or_b32 v41, v34, 16, v33
    v_lshl_or_b32 v42, v35, 16, v34
    v_lshl_or_b32 v43, v36, 16, v35
    v_lshl_or_b32 v44, v37, 16, v36
    v_lshl_or_b32 v45, v38, 16, v37
    v_add_u32 v7, 32, v6
    ds_write2_b32 v7, v43, v45 offset0:0 offset1:1
    v_add_u32 v7, 4256, v6
    ds_write2_b32 v7, v42, v44 offset0:0 offset1:1
    v_add_u32 v7, 8480, v6
    ds_write2_b32 v7, v41, v43 offset0:0 offset1:1
    v_add_u32 v7, 12704, v6
    ds_write2_b32 v7, v40, v42 offset0:0 offset1:1
    s_waitcnt lgkmcnt(11)
    v_lshl_or_b32 v56, v49, 16, v48
    v_lshl_or_b32 v57, v50, 16, v49
    v_lshl_or_b32 v58, v51, 16, v50
    v_lshl_or_b32 v59, v52, 16, v51
    v_lshl_or_b32 v60, v53, 16, v52
    v_lshl_or_b32 v61, v54, 16, v53
    v_add_u32 v7, 16928, v6
    ds_write2_b32 v7, v59, v61 offset0:0 offset1:1
    v_add_u32 v7, 21152, v6
    ds_write2_b32 v7, v58, v60 offset0:0 offset1:1
    v_add_u32 v7, 25376, v6
    ds_write2_b32 v7, v57, v59 offset0:0 offset1:1
    v_add_u32 v7, 29600, v6
    ds_write2_b32 v7, v56, v58 offset0:0 offset1:1
    s_waitcnt lgkmcnt(8)
    v_lshl_or_b32 v72, v65, 16, v64
    v_lshl_or_b32 v73, v66, 16, v65
    v_lshl_or_b32 v74, v67, 16, v66
    v_lshl_or_b32 v75, v68, 16, v67
    v_lshl_or_b32 v76, v69, 16, v68
    v_lshl_or_b32 v77, v70, 16, v69
    v_add_u32 v7, 33824, v6
    ds_write2_b32 v7, v75, v77 offset0:0 offset1:1
    v_add_u32 v7, 38048, v6
    ds_write2_b32 v7, v74, v76 offset0:0 offset1:1
    v_add_u32 v7, 42272, v6
    ds_write2_b32 v7, v73, v75 offset0:0 offset1:1
    v_add_u32 v7, 46496, v6
    ds_write2_b32 v7, v72, v74 offset0:0 offset1:1
    v_cmp_gt_u32 vcc, 256, v0
    s_waitcnt vmcnt(1)
    ds_write_b32 v161, v8
    ds_write_b32 v161, v9 offset:1152
    ds_write_b32 v161, v10 offset:2304
    ds_write_b32 v161, v11 offset:3456
    s_waitcnt vmcnt(0)
    s_and_saveexec_b64 s[4:5], vcc
    ds_write_b32 v163, v12
    ds_write_b32 v163, v13 offset:1152
    ds_write_b32 v163, v14 offset:2304
    ds_write_b32 v163, v15 offset:3456
    s_mov_b64 exec, s[4:5]
    s_cmp_lt_u32 s20, 6
    s_cbranch_scc1 L_np_43
    s_mov_b32 s8, s40
    s_mov_b32 s9, s41
    s_mov_b32 s36, s66
    s_and_b32 s37, s67, 0xffff
    s_mov_b32 s38, 2211840
    s_mov_b32 s39, 0x00020000
    s_mov_b32 s40, s68
    s_and_b32 s41, s69, 0xffff
    s_mov_b32 s42, 2211840
    s_mov_b32 s43, 0x00020000
    s_mov_b32 s44, s70
    s_and_b32 s45, s71, 0xffff
    s_mov_b32 s46, 2211840
    s_mov_b32 s47, 0x00020000
    s_and_b32 s4, s2, 7
    s_lshr_b32 s5, s2, 3
    s_mul_i32 s6, s4, 432
    s_mul_i32 s7, s5, 69120
    s_add_u32 s6, s6, s7
    v_lshrrev_b32 v5, 5, v2
    v_mul_u32_u24 v5, 3456, v5
    v_and_b32 v6, 31, v2
    v_lshl_add_u32 v5, v6, 4, v5
    v_mov_b32 v7, 0x7ffffff0
    v_cmp_gt_u32 vcc, 27, v6
    s_cmp_eq_u32 s20, 6
    s_cselect_b32 s36, s36, s40
    v_cndmask_b32 v5, v7, v5, vcc
    s_cselect_b32 s37, s37, s41
    s_add_u32 s7, s6, 0
    buffer_load_dwordx4 v[216:219], v5, s[36:39], s7 offen
    s_add_u32 s7, s6, 6912
    buffer_load_dwordx4 v[220:223], v5, s[36:39], s7 offen
    s_add_u32 s7, s6, 13824
    buffer_load_dwordx4 v[216:219], v5, s[36:39], s7 offen
    s_add_u32 s7, s6, 20736
    buffer_load_dwordx4 v[220:223], v5, s[36:39], s7 offen
    s_add_u32 s7, s6, 27648
    buffer_load_dwordx4 v[216:219], v5, s[36:39], s7 offen
    s_add_u32 s7, s6, 34560
    buffer_load_dwordx4 v[220:223], v5, s[36:39], s7 offen
    s_add_u32 s7, s6, 41472
    buffer_load_dwordx4 v[216:219], v5, s[36:39], s7 offen
    s_add_u32 s7, s6, 48384
    buffer_load_dwordx4 v[220:223], v5, s[36:39], s7 offen
    s_add_u32 s7, s6, 55296
    buffer_load_dwordx4 v[216:219], v5, s[36:39], s7 offen
    s_add_u32 s7, s6, 62208
    buffer_load_dwordx4 v[220:223], v5, s[36:39], s7 offen
    s_mov_b32 s40, s8
    s_mov_b32 s41, s9
L_np_43:
    v_mov_b32 v46, 0
    v_mov_b32 v47, 0
    v_lshlrev_b32 v48, 3, v0
    s_mul_i32 s5, s2, 5120
    s_add_u32 s5, s5, 5373952
    buffer_store_dwordx2 v[46:47], v48, s[32:35], s5 offen sc1
    s_cmp_ge_u32 s20, 2
    s_cbranch_scc1 L_zero_44
    s_add_u32 s5, s5, 4096
    buffer_store_dwordx2 v[46:47], v48, s[32:35], s5 offen sc1
    s_cmp_ge_u32 s20, 1
    s_cbranch_scc1 L_zero_44
    s_mov_b64 exec, 0x3
    v_lshlrev_b32 v48, 12, v0
    s_lshl_b32 s5, s2, 4
    s_add_u32 s5, s5, 5242880
    buffer_store_dword v46, v48, s[32:35], s5 offen sc1
    v_lshlrev_b32 v48, 7, v0
    s_and_b32 s5, s2, 7
    s_lshl_b32 s5, s5, 12
    s_add_u32 s5, s5, 5275648
    s_cmp_lt_u32 s2, 8
    s_cselect_b32 s5, s5, 0x40000000
    buffer_store_dwordx2 v[46:47], v48, s[32:35], s5 offen sc1
    s_mov_b64 exec, -1
L_zero_44:
    s_cmp_ge_u32 s2, 216
    s_cbranch_scc1 L_zero2_45
    s_cmp_lt_u32 s20, 3
    s_cbranch_scc1 L_zero3_46
    s_mul_i32 s5, s2, 2560
    s_add_u32 s5, s5, 7076352
    v_lshlrev_b32 v48, 3, v0
    buffer_store_dwordx2 v[46:47], v48, s[32:35], s5 offen sc1
    s_add_u32 s5, s5, 1048576
    buffer_store_dwordx2 v[46:47], v48, s[32:35], s5 offen sc1
    s_branch L_zero2_45
L_zero3_46:
L_zero2_45:
    s_mov_b32 s28, s64
    s_and_b32 s29, s65, 0xffff
    s_mov_b32 s30, 1280
    s_mov_b32 s31, 0x00020000
    buffer_load_dwordx4 v[160:163], v3, s[28:31], 0 offen
    buffer_load_dword v205, v4, s[28:31], 0 offen offset:1024
    v_lshrrev_b32 v8, 4, v2
    v_mul_u32_u24 v9, 4224, v8
    v_bfe_u32 v10, v2, 2, 2
    v_and_b32 v11, 3, v2
    v_sub_u32 v10, v11, v10
    v_lshl_add_u32 v9, v10, 3, v9
    v_add_u32 v9, 32, v9
    v_mul_u32_u24 v10, 1152, v8
    v_and_b32 v11, 15, v2
    v_lshl_add_u32 v10, v11, 3, v10
    v_add_u32 v10, 107816, v10
    v_lshlrev_b32 v12, 5, v11
    v_lshl_add_u32 v12, v8, 3, v12
    v_lshlrev_b32 v13, 4, v2
    v_mov_b32 v5, 121648
    ds_read_b96 v[20:22], v5
    v_mov_b32 v24, 0
    v_mov_b32 v25, 0
    v_mov_b32 v26, 0
    v_mov_b32 v27, 0
    v_mov_b32 v28, 0
    v_mov_b32 v29, 0
    v_mov_b32 v30, 0
    v_mov_b32 v31, 0
    v_mov_b32 v32, 0
    v_mov_b32 v33, 0
    v_mov_b32 v34, 0
    v_mov_b32 v35, 0
    v_mov_b32 v36, 0
    v_mov_b32 v37, 0
    v_mov_b32 v38, 0
    v_mov_b32 v39, 0
    v_mov_b32 v40, 0
    v_mov_b32 v41, 0
    v_mov_b32 v42, 0
    v_mov_b32 v43, 0
    v_mov_b32 v44, 0
    v_mov_b32 v45, 0
    v_mov_b32 v46, 0
    v_mov_b32 v47, 0
    v_mov_b32 v48, 0
    v_mov_b32 v49, 0
    v_mov_b32 v50, 0
    v_mov_b32 v51, 0
    v_mov_b32 v52, 0
    v_mov_b32 v53, 0
    v_mov_b32 v54, 0
    v_mov_b32 v55, 0
    v_mov_b32 v196, 0
    v_mov_b32 v197, 0
    v_mov_b32 v198, 0
    v_mov_b32 v199, 0
    v_mov_b32 v212, 0
    v_mov_b32 v213, 0
    v_mov_b32 v214, 0
    v_mov_b32 v215, 0
    v_mov_b32 v152, 0
    v_mov_b32 v153, 0
    v_mov_b32 v154, 0
    v_mov_b32 v155, 0
    v_mov_b32 v156, 0
    v_mov_b32 v157, 0
    v_mov_b32 v158, 0
    v_mov_b32 v159, 0
    v_mov_b32 v164, 0
    v_mov_b32 v165, 0
    v_mov_b32 v166, 0
    v_mov_b32 v167, 0
    s_lshr_b32 s4, s20, 1
    s_and_b32 s5, s20, 1
    s_lshl_b32 s6, s5, 2
    s_mul_i32 s7, s4, 16896
    s_sub_u32 s8, 4, s6
    s_lshl_b32 s8, s8, 6
    s_add_u32 s7, s7, s8
    v_add_u32 v14, s7, v9
    s_mul_i32 s7, s4, 4608
    s_lshl_b32 s8, s6, 4
    s_add_u32 s7, s7, s8
    v_add_u32 v15, s7, v10
    s_waitcnt lgkmcnt(0)
    v_readfirstlane_b32 s48, v20
    v_readfirstlane_b32 s49, v21
    v_readfirstlane_b32 s50, v22
    s_lshl_b32 s6, s20, 1
    s_sub_u32 s8, 4, s6
    s_lshl_b32 s8, s8, 6
    s_add_u32 s7, s8, 33792
    v_add_u32 v22, s7, v9
    s_lshl_b32 s8, s6, 4
    s_add_u32 s7, s8, 9216
    v_add_u32 v19, s7, v10
    s_lshl_b32 s11, s20, 10
    s_add_u32 s11, s11, 83456
    v_add_u32 v20, s11, v13
    s_lshl_b32 s10, s20, 11
    s_add_u32 s10, s10, s3
    v_add_u32 v13, 50688, v13
    v_lshlrev_b32 v18, 6, v11
    v_lshl_add_u32 v18, v8, 4, v18
    s_barrier
    s_cmp_ge_u32 s20, 4
    s_cbranch_scc1 L_shared_47
    ds_read_b64_tr_b16 v[56:57], v14 offset:224
    ds_read_b64_tr_b16 v[58:59], v14 offset:192
    ds_read_b64 v[88:89], v15 offset:0
    ds_read_b64 v[90:91], v15 offset:8
    ds_read_b64_tr_b16 v[60:61], v14 offset:736
    ds_read_b64_tr_b16 v[62:63], v14 offset:704
    ds_read_b64 v[92:93], v15 offset:128
    ds_read_b64 v[94:95], v15 offset:136
    ds_read_b64_tr_b16 v[64:65], v14 offset:1248
    ds_read_b64_tr_b16 v[66:67], v14 offset:1216
    ds_read_b64 v[96:97], v15 offset:256
    ds_read_b64 v[98:99], v15 offset:264
    s_waitcnt lgkmcnt(8)
    v_mfma_f32_16x16x32_f16 v[24:27], v[56:59], v[88:91], v[24:27]
    ds_read_b64_tr_b16 v[68:69], v14 offset:1760
    ds_read_b64_tr_b16 v[70:71], v14 offset:1728
    ds_read_b64 v[100:101], v15 offset:384
    ds_read_b64 v[102:103], v15 offset:392
    s_waitcnt lgkmcnt(8)
    v_mfma_f32_16x16x32_f16 v[28:31], v[60:63], v[88:91], v[28:31]
    ds_read_b64_tr_b16 v[72:73], v14 offset:2272
    ds_read_b64_tr_b16 v[74:75], v14 offset:2240
    v_mfma_f32_16x16x32_f16 v[32:35], v[60:63], v[92:95], v[32:35]
    ds_read_b64 v[104:105], v15 offset:512
    ds_read_b64 v[106:107], v15 offset:520
    v_mfma_f32_16x16x32_f16 v[28:31], v[56:59], v[92:95], v[28:31]
    ds_read_b64_tr_b16 v[76:77], v14 offset:2784
    ds_read_b64_tr_b16 v[78:79], v14 offset:2752
    s_waitcnt lgkmcnt(10)
    v_mfma_f32_16x16x32_f16 v[32:35], v[64:67], v[88:91], v[32:35]
    ds_read_b64 v[108:109], v15 offset:640
    ds_read_b64 v[110:111], v15 offset:648
    v_mfma_f32_16x16x32_f16 v[36:39], v[64:67], v[92:95], v[36:39]
    ds_read_b64_tr_b16 v[80:81], v14 offset:3296
    ds_read_b64_tr_b16 v[82:83], v14 offset:3264
    v_mfma_f32_16x16x32_f16 v[40:43], v[64:67], v[96:99], v[40:43]
    ds_read_b64 v[112:113], v15 offset:768
    ds_read_b64 v[114:115], v15 offset:776
    v_mfma_f32_16x16x32_f16 v[32:35], v[56:59], v[96:99], v[32:35]
    ds_read_b64_tr_b16 v[84:85], v14 offset:3808
    ds_read_b64_tr_b16 v[86:87], v14 offset:3776
    v_mfma_f32_16x16x32_f16 v[36:39], v[60:63], v[96:99], v[36:39]
    ds_read_b64 v[116:117], v15 offset:896
    ds_read_b64 v[118:119], v15 offset:904
    s_waitcnt lgkmcnt(15)
    v_mfma_f32_16x16x32_f16 v[36:39], v[68:71], v[88:91], v[36:39]
    ds_read_b64_tr_b16 v[120:121], v14 offset:160
    ds_read_b64_tr_b16 v[122:123], v14 offset:128
    v_mfma_f32_16x16x32_f16 v[40:43], v[68:71], v[92:95], v[40:43]
    ds_read_b64 v[216:217], v15 offset:16
    ds_read_b64 v[218:219], v15 offset:24
    v_mfma_f32_16x16x32_f16 v[44:47], v[68:71], v[96:99], v[44:47]
    ds_read_b64_tr_b16 v[124:125], v14 offset:672
    ds_read_b64_tr_b16 v[126:127], v14 offset:640
    v_mfma_f32_16x16x32_f16 v[48:51], v[68:71], v[100:103], v[48:51]
    ds_read_b64 v[220:221], v15 offset:144
    ds_read_b64 v[222:223], v15 offset:152
    v_mfma_f32_16x16x32_f16 v[36:39], v[56:59], v[100:103], v[36:39]
    ds_read_b64_tr_b16 v[128:129], v14 offset:1184
    v_mfma_f32_16x16x32_f16 v[40:43], v[60:63], v[100:103], v[40:43]
    ds_read_b64_tr_b16 v[130:131], v14 offset:1152
    v_mfma_f32_16x16x32_f16 v[44:47], v[64:67], v[100:103], v[44:47]
    ds_read_b64 v[224:225], v15 offset:272
    s_waitcnt lgkmcnt(15)
    v_mfma_f32_16x16x32_f16 v[40:43], v[72:75], v[88:91], v[40:43]
    ds_read_b64 v[226:227], v15 offset:280
    v_mfma_f32_16x16x32_f16 v[44:47], v[72:75], v[92:95], v[44:47]
    ds_read_b64_tr_b16 v[132:133], v14 offset:1696
    v_mfma_f32_16x16x32_f16 v[48:51], v[72:75], v[96:99], v[48:51]
    ds_read_b64_tr_b16 v[134:135], v14 offset:1664
    v_mfma_f32_16x16x32_f16 v[52:55], v[72:75], v[100:103], v[52:55]
    ds_read_b64 v[228:229], v15 offset:400
    v_mfma_f32_16x16x32_f16 v[40:43], v[56:59], v[104:107], v[40:43]
    ds_read_b64 v[230:231], v15 offset:408
    v_mfma_f32_16x16x32_f16 v[44:47], v[60:63], v[104:107], v[44:47]
    ds_read_b64_tr_b16 v[136:137], v14 offset:2208
    v_mfma_f32_16x16x32_f16 v[48:51], v[64:67], v[104:107], v[48:51]
    ds_read_b64_tr_b16 v[138:139], v14 offset:2176
    v_mfma_f32_16x16x32_f16 v[52:55], v[68:71], v[104:107], v[52:55]
    ds_read_b64 v[232:233], v15 offset:528
    s_waitcnt lgkmcnt(15)
    v_mfma_f32_16x16x32_f16 v[44:47], v[76:79], v[88:91], v[44:47]
    ds_read_b64 v[234:235], v15 offset:536
    v_mfma_f32_16x16x32_f16 v[48:51], v[76:79], v[92:95], v[48:51]
    ds_read_b64_tr_b16 v[140:141], v14 offset:2720
    v_mfma_f32_16x16x32_f16 v[52:55], v[76:79], v[96:99], v[52:55]
    ds_read_b64_tr_b16 v[142:143], v14 offset:2688
    v_mfma_f32_16x16x32_f16 v[44:47], v[56:59], v[108:111], v[44:47]
    ds_read_b64 v[236:237], v15 offset:656
    v_mfma_f32_16x16x32_f16 v[48:51], v[60:63], v[108:111], v[48:51]
    ds_read_b64 v[238:239], v15 offset:664
    v_mfma_f32_16x16x32_f16 v[52:55], v[64:67], v[108:111], v[52:55]
    ds_read_b64_tr_b16 v[144:145], v14 offset:3232
    s_waitcnt lgkmcnt(15)
    v_mfma_f32_16x16x32_f16 v[48:51], v[80:83], v[88:91], v[48:51]
    ds_read_b64_tr_b16 v[146:147], v14 offset:3200
    v_mfma_f32_16x16x32_f16 v[52:55], v[80:83], v[92:95], v[52:55]
    ds_read_b64 v[240:241], v15 offset:784
    v_mfma_f32_16x16x32_f16 v[48:51], v[56:59], v[112:115], v[48:51]
    ds_read_b64 v[242:243], v15 offset:792
    v_mfma_f32_16x16x32_f16 v[52:55], v[60:63], v[112:115], v[52:55]
    ds_read_b64_tr_b16 v[148:149], v14 offset:3744
    s_waitcnt lgkmcnt(15)
    v_mfma_f32_16x16x32_f16 v[52:55], v[84:87], v[88:91], v[52:55]
    ds_read_b64_tr_b16 v[150:151], v14 offset:3712
    v_mfma_f32_16x16x32_f16 v[52:55], v[56:59], v[116:119], v[52:55]
    ds_read_b64 v[244:245], v15 offset:912
    ds_read_b64 v[246:247], v15 offset:920
    s_waitcnt lgkmcnt(15)
    v_mfma_f32_16x16x32_f16 v[24:27], v[120:123], v[216:219], v[24:27]
    ds_read_b64_tr_b16 v[56:57], v14 offset:96
    s_waitcnt lgkmcnt(15)
    v_mfma_f32_16x16x32_f16 v[28:31], v[124:127], v[216:219], v[28:31]
    ds_read_b64_tr_b16 v[58:59], v14 offset:64
    v_mfma_f32_16x16x32_f16 v[32:35], v[124:127], v[220:223], v[32:35]
    ds_read_b64 v[88:89], v15 offset:32
    v_mfma_f32_16x16x32_f16 v[28:31], v[120:123], v[220:223], v[28:31]
    ds_read_b64 v[90:91], v15 offset:40
    s_waitcnt lgkmcnt(15)
    v_mfma_f32_16x16x32_f16 v[32:35], v[128:131], v[216:219], v[32:35]
    ds_read_b64_tr_b16 v[60:61], v14 offset:608
    v_mfma_f32_16x16x32_f16 v[36:39], v[128:131], v[220:223], v[36:39]
    ds_read_b64_tr_b16 v[62:63], v14 offset:576
    v_mfma_f32_16x16x32_f16 v[40:43], v[128:131], v[224:227], v[40:43]
    ds_read_b64 v[92:93], v15 offset:160
    v_mfma_f32_16x16x32_f16 v[32:35], v[120:123], v[224:227], v[32:35]
    ds_read_b64 v[94:95], v15 offset:168
    v_mfma_f32_16x16x32_f16 v[36:39], v[124:127], v[224:227], v[36:39]
    ds_read_b64_tr_b16 v[64:65], v14 offset:1120
    s_waitcnt lgkmcnt(15)
    v_mfma_f32_16x16x32_f16 v[36:39], v[132:135], v[216:219], v[36:39]
    ds_read_b64_tr_b16 v[66:67], v14 offset:1088
    v_mfma_f32_16x16x32_f16 v[40:43], v[132:135], v[220:223], v[40:43]
    ds_read_b64 v[96:97], v15 offset:288
    v_mfma_f32_16x16x32_f16 v[44:47], v[132:135], v[224:227], v[44:47]
    ds_read_b64 v[98:99], v15 offset:296
    v_mfma_f32_16x16x32_f16 v[48:51], v[132:135], v[228:231], v[48:51]
    ds_read_b64_tr_b16 v[68:69], v14 offset:1632
    v_mfma_f32_16x16x32_f16 v[36:39], v[120:123], v[228:231], v[36:39]
    ds_read_b64_tr_b16 v[70:71], v14 offset:1600
    v_mfma_f32_16x16x32_f16 v[40:43], v[124:127], v[228:231], v[40:43]
    ds_read_b64 v[100:101], v15 offset:416
    v_mfma_f32_16x16x32_f16 v[44:47], v[128:131], v[228:231], v[44:47]
    ds_read_b64 v[102:103], v15 offset:424
    s_waitcnt lgkmcnt(15)
    v_mfma_f32_16x16x32_f16 v[40:43], v[136:139], v[216:219], v[40:43]
    ds_read_b64_tr_b16 v[72:73], v14 offset:2144
    v_mfma_f32_16x16x32_f16 v[44:47], v[136:139], v[220:223], v[44:47]
    ds_read_b64_tr_b16 v[74:75], v14 offset:2112
    v_mfma_f32_16x16x32_f16 v[48:51], v[136:139], v[224:227], v[48:51]
    ds_read_b64 v[104:105], v15 offset:544
    v_mfma_f32_16x16x32_f16 v[52:55], v[136:139], v[228:231], v[52:55]
    ds_read_b64 v[106:107], v15 offset:552
    v_mfma_f32_16x16x32_f16 v[40:43], v[120:123], v[232:235], v[40:43]
    ds_read_b64_tr_b16 v[76:77], v14 offset:2656
    v_mfma_f32_16x16x32_f16 v[44:47], v[124:127], v[232:235], v[44:47]
    ds_read_b64_tr_b16 v[78:79], v14 offset:2624
    v_mfma_f32_16x16x32_f16 v[48:51], v[128:131], v[232:235], v[48:51]
    ds_read_b64 v[108:109], v15 offset:672
    v_mfma_f32_16x16x32_f16 v[52:55], v[132:135], v[232:235], v[52:55]
    ds_read_b64 v[110:111], v15 offset:680
    s_waitcnt lgkmcnt(15)
    v_mfma_f32_16x16x32_f16 v[44:47], v[140:143], v[216:219], v[44:47]
    ds_read_b64_tr_b16 v[80:81], v14 offset:3168
    v_mfma_f32_16x16x32_f16 v[48:51], v[140:143], v[220:223], v[48:51]
    ds_read_b64_tr_b16 v[82:83], v14 offset:3136
    v_mfma_f32_16x16x32_f16 v[52:55], v[140:143], v[224:227], v[52:55]
    ds_read_b64 v[112:113], v15 offset:800
    v_mfma_f32_16x16x32_f16 v[44:47], v[120:123], v[236:239], v[44:47]
    ds_read_b64 v[114:115], v15 offset:808
    v_mfma_f32_16x16x32_f16 v[48:51], v[124:127], v[236:239], v[48:51]
    ds_read_b64_tr_b16 v[84:85], v14 offset:3680
    v_mfma_f32_16x16x32_f16 v[52:55], v[128:131], v[236:239], v[52:55]
    ds_read_b64_tr_b16 v[86:87], v14 offset:3648
    s_waitcnt lgkmcnt(15)
    v_mfma_f32_16x16x32_f16 v[48:51], v[144:147], v[216:219], v[48:51]
    ds_read_b64 v[116:117], v15 offset:928
    v_mfma_f32_16x16x32_f16 v[52:55], v[144:147], v[220:223], v[52:55]
    ds_read_b64 v[118:119], v15 offset:936
    v_mfma_f32_16x16x32_f16 v[48:51], v[120:123], v[240:243], v[48:51]
    v_mfma_f32_16x16x32_f16 v[52:55], v[124:127], v[240:243], v[52:55]
    s_waitcnt lgkmcnt(15)
    v_mfma_f32_16x16x32_f16 v[52:55], v[148:151], v[216:219], v[52:55]
    v_mfma_f32_16x16x32_f16 v[52:55], v[120:123], v[244:247], v[52:55]
    s_waitcnt lgkmcnt(15)
    v_mfma_f32_16x16x32_f16 v[24:27], v[56:59], v[88:91], v[24:27]
    ds_read_b64_tr_b16 v[120:121], v14 offset:32
    s_waitcnt lgkmcnt(15)
    v_mfma_f32_16x16x32_f16 v[28:31], v[60:63], v[88:91], v[28:31]
    ds_read_b64_tr_b16 v[122:123], v14 offset:0
    v_mfma_f32_16x16x32_f16 v[32:35], v[60:63], v[92:95], v[32:35]
    ds_read_b64 v[216:217], v15 offset:48
    v_mfma_f32_16x16x32_f16 v[28:31], v[56:59], v[92:95], v[28:31]
    ds_read_b64 v[218:219], v15 offset:56
    s_waitcnt lgkmcnt(15)
    v_mfma_f32_16x16x32_f16 v[32:35], v[64:67], v[88:91], v[32:35]
    ds_read_b64_tr_b16 v[124:125], v14 offset:544
    v_mfma_f32_16x16x32_f16 v[36:39], v[64:67], v[92:95], v[36:39]
    ds_read_b64_tr_b16 v[126:127], v14 offset:512
    v_mfma_f32_16x16x32_f16 v[40:43], v[64:67], v[96:99], v[40:43]
    ds_read_b64 v[220:221], v15 offset:176
    v_mfma_f32_16x16x32_f16 v[32:35], v[56:59], v[96:99], v[32:35]
    ds_read_b64 v[222:223], v15 offset:184
    v_mfma_f32_16x16x32_f16 v[36:39], v[60:63], v[96:99], v[36:39]
    ds_read_b64_tr_b16 v[128:129], v14 offset:1056
    s_waitcnt lgkmcnt(15)
    v_mfma_f32_16x16x32_f16 v[36:39], v[68:71], v[88:91], v[36:39]
    ds_read_b64_tr_b16 v[130:131], v14 offset:1024
    v_mfma_f32_16x16x32_f16 v[40:43], v[68:71], v[92:95], v[40:43]
    ds_read_b64 v[224:225], v15 offset:304
    v_mfma_f32_16x16x32_f16 v[44:47], v[68:71], v[96:99], v[44:47]
    ds_read_b64 v[226:227], v15 offset:312
    v_mfma_f32_16x16x32_f16 v[48:51], v[68:71], v[100:103], v[48:51]
    ds_read_b64_tr_b16 v[132:133], v14 offset:1568
    v_mfma_f32_16x16x32_f16 v[36:39], v[56:59], v[100:103], v[36:39]
    ds_read_b64_tr_b16 v[134:135], v14 offset:1536
    v_mfma_f32_16x16x32_f16 v[40:43], v[60:63], v[100:103], v[40:43]
    ds_read_b64 v[228:229], v15 offset:432
    v_mfma_f32_16x16x32_f16 v[44:47], v[64:67], v[100:103], v[44:47]
    ds_read_b64 v[230:231], v15 offset:440
    s_waitcnt lgkmcnt(15)
    v_mfma_f32_16x16x32_f16 v[40:43], v[72:75], v[88:91], v[40:43]
    ds_read_b64_tr_b16 v[136:137], v14 offset:2080
    v_mfma_f32_16x16x32_f16 v[44:47], v[72:75], v[92:95], v[44:47]
    ds_read_b64_tr_b16 v[138:139], v14 offset:2048
    v_mfma_f32_16x16x32_f16 v[48:51], v[72:75], v[96:99], v[48:51]
    ds_read_b64 v[232:233], v15 offset:560
    v_mfma_f32_16x16x32_f16 v[52:55], v[72:75], v[100:103], v[52:55]
    ds_read_b64 v[234:235], v15 offset:568
    v_mfma_f32_16x16x32_f16 v[40:43], v[56:59], v[104:107], v[40:43]
    ds_read_b64_tr_b16 v[140:141], v14 offset:2592
    v_mfma_f32_16x16x32_f16 v[44:47], v[60:63], v[104:107], v[44:47]
    ds_read_b64_tr_b16 v[142:143], v14 offset:2560
    v_mfma_f32_16x16x32_f16 v[48:51], v[64:67], v[104:107], v[48:51]
    ds_read_b64 v[236:237], v15 offset:688
    v_mfma_f32_16x16x32_f16 v[52:55], v[68:71], v[104:107], v[52:55]
    ds_read_b64 v[238:239], v15 offset:696
    s_waitcnt lgkmcnt(15)
    v_mfma_f32_16x16x32_f16 v[44:47], v[76:79], v[88:91], v[44:47]
    ds_read_b64_tr_b16 v[144:145], v14 offset:3104
    v_mfma_f32_16x16x32_f16 v[48:51], v[76:79], v[92:95], v[48:51]
    ds_read_b64_tr_b16 v[146:147], v14 offset:3072
    v_mfma_f32_16x16x32_f16 v[52:55], v[76:79], v[96:99], v[52:55]
    ds_read_b64 v[240:241], v15 offset:816
    v_mfma_f32_16x16x32_f16 v[44:47], v[56:59], v[108:111], v[44:47]
    ds_read_b64 v[242:243], v15 offset:824
    v_mfma_f32_16x16x32_f16 v[48:51], v[60:63], v[108:111], v[48:51]
    ds_read_b64_tr_b16 v[148:149], v14 offset:3616
    v_mfma_f32_16x16x32_f16 v[52:55], v[64:67], v[108:111], v[52:55]
    ds_read_b64_tr_b16 v[150:151], v14 offset:3584
    s_waitcnt lgkmcnt(15)
    v_mfma_f32_16x16x32_f16 v[48:51], v[80:83], v[88:91], v[48:51]
    ds_read_b64 v[244:245], v15 offset:944
    v_mfma_f32_16x16x32_f16 v[52:55], v[80:83], v[92:95], v[52:55]
    ds_read_b64 v[246:247], v15 offset:952
    v_mfma_f32_16x16x32_f16 v[48:51], v[56:59], v[112:115], v[48:51]
    v_mfma_f32_16x16x32_f16 v[52:55], v[60:63], v[112:115], v[52:55]
    s_waitcnt lgkmcnt(15)
    v_mfma_f32_16x16x32_f16 v[52:55], v[84:87], v[88:91], v[52:55]
    v_mfma_f32_16x16x32_f16 v[52:55], v[56:59], v[116:119], v[52:55]
    s_waitcnt lgkmcnt(15)
    v_mfma_f32_16x16x32_f16 v[24:27], v[120:123], v[216:219], v[24:27]
    ds_read_b64_tr_b16 v[56:57], v22 offset:224
    s_waitcnt lgkmcnt(15)
    v_mfma_f32_16x16x32_f16 v[28:31], v[124:127], v[216:219], v[28:31]
    ds_read_b64_tr_b16 v[58:59], v22 offset:192
    v_mfma_f32_16x16x32_f16 v[32:35], v[124:127], v[220:223], v[32:35]
    ds_read_b64 v[88:89], v19 offset:0
    v_mfma_f32_16x16x32_f16 v[28:31], v[120:123], v[220:223], v[28:31]
    ds_read_b64 v[90:91], v19 offset:8
    s_waitcnt lgkmcnt(15)
    v_mfma_f32_16x16x32_f16 v[32:35], v[128:131], v[216:219], v[32:35]
    ds_read_b64_tr_b16 v[60:61], v22 offset:736
    v_mfma_f32_16x16x32_f16 v[36:39], v[128:131], v[220:223], v[36:39]
    ds_read_b64_tr_b16 v[62:63], v22 offset:704
    v_mfma_f32_16x16x32_f16 v[40:43], v[128:131], v[224:227], v[40:43]
    ds_read_b64 v[92:93], v19 offset:128
    v_mfma_f32_16x16x32_f16 v[32:35], v[120:123], v[224:227], v[32:35]
    ds_read_b64 v[94:95], v19 offset:136
    v_mfma_f32_16x16x32_f16 v[36:39], v[124:127], v[224:227], v[36:39]
    ds_read_b64_tr_b16 v[64:65], v22 offset:1248
    s_waitcnt lgkmcnt(15)
    v_mfma_f32_16x16x32_f16 v[36:39], v[132:135], v[216:219], v[36:39]
    ds_read_b64_tr_b16 v[66:67], v22 offset:1216
    v_mfma_f32_16x16x32_f16 v[40:43], v[132:135], v[220:223], v[40:43]
    ds_read_b64 v[96:97], v19 offset:256
    v_mfma_f32_16x16x32_f16 v[44:47], v[132:135], v[224:227], v[44:47]
    ds_read_b64 v[98:99], v19 offset:264
    v_mfma_f32_16x16x32_f16 v[48:51], v[132:135], v[228:231], v[48:51]
    ds_read_b64_tr_b16 v[68:69], v22 offset:1760
    v_mfma_f32_16x16x32_f16 v[36:39], v[120:123], v[228:231], v[36:39]
    ds_read_b64_tr_b16 v[70:71], v22 offset:1728
    v_mfma_f32_16x16x32_f16 v[40:43], v[124:127], v[228:231], v[40:43]
    ds_read_b64 v[100:101], v19 offset:384
    v_mfma_f32_16x16x32_f16 v[44:47], v[128:131], v[228:231], v[44:47]
    ds_read_b64 v[102:103], v19 offset:392
    s_waitcnt lgkmcnt(15)
    v_mfma_f32_16x16x32_f16 v[40:43], v[136:139], v[216:219], v[40:43]
    ds_read_b64_tr_b16 v[72:73], v22 offset:2272
    v_mfma_f32_16x16x32_f16 v[44:47], v[136:139], v[220:223], v[44:47]
    ds_read_b64_tr_b16 v[74:75], v22 offset:2240
    v_mfma_f32_16x16x32_f16 v[48:51], v[136:139], v[224:227], v[48:51]
    ds_read_b64 v[104:105], v19 offset:512
    v_mfma_f32_16x16x32_f16 v[52:55], v[136:139], v[228:231], v[52:55]
    ds_read_b64 v[106:107], v19 offset:520
    v_mfma_f32_16x16x32_f16 v[40:43], v[120:123], v[232:235], v[40:43]
    ds_read_b64_tr_b16 v[76:77], v22 offset:2784
    v_mfma_f32_16x16x32_f16 v[44:47], v[124:127], v[232:235], v[44:47]
    ds_read_b64_tr_b16 v[78:79], v22 offset:2752
    v_mfma_f32_16x16x32_f16 v[48:51], v[128:131], v[232:235], v[48:51]
    ds_read_b64 v[108:109], v19 offset:640
    v_mfma_f32_16x16x32_f16 v[52:55], v[132:135], v[232:235], v[52:55]
    ds_read_b64 v[110:111], v19 offset:648
    s_waitcnt lgkmcnt(15)
    v_mfma_f32_16x16x32_f16 v[44:47], v[140:143], v[216:219], v[44:47]
    ds_read_b64_tr_b16 v[80:81], v22 offset:3296
    v_mfma_f32_16x16x32_f16 v[48:51], v[140:143], v[220:223], v[48:51]
    ds_read_b64_tr_b16 v[82:83], v22 offset:3264
    v_mfma_f32_16x16x32_f16 v[52:55], v[140:143], v[224:227], v[52:55]
    ds_read_b64 v[112:113], v19 offset:768
    v_mfma_f32_16x16x32_f16 v[44:47], v[120:123], v[236:239], v[44:47]
    ds_read_b64 v[114:115], v19 offset:776
    v_mfma_f32_16x16x32_f16 v[48:51], v[124:127], v[236:239], v[48:51]
    ds_read_b64_tr_b16 v[84:85], v22 offset:3808
    v_mfma_f32_16x16x32_f16 v[52:55], v[128:131], v[236:239], v[52:55]
    ds_read_b64_tr_b16 v[86:87], v22 offset:3776
    s_waitcnt lgkmcnt(15)
    v_mfma_f32_16x16x32_f16 v[48:51], v[144:147], v[216:219], v[48:51]
    ds_read_b64 v[116:117], v19 offset:896
    v_mfma_f32_16x16x32_f16 v[52:55], v[144:147], v[220:223], v[52:55]
    ds_read_b64 v[118:119], v19 offset:904
    v_mfma_f32_16x16x32_f16 v[48:51], v[120:123], v[240:243], v[48:51]
    v_mfma_f32_16x16x32_f16 v[52:55], v[124:127], v[240:243], v[52:55]
    s_waitcnt lgkmcnt(15)
    v_mfma_f32_16x16x32_f16 v[52:55], v[148:151], v[216:219], v[52:55]
    v_mfma_f32_16x16x32_f16 v[52:55], v[120:123], v[244:247], v[52:55]
    s_cmp_eq_u32 s61, 1
    s_cbranch_scc1 L_so_49
    s_waitcnt lgkmcnt(15)
    v_mfma_f32_16x16x32_f16 v[196:199], v[56:59], v[88:91], v[196:199]
    ds_read_b64_tr_b16 v[120:121], v22 offset:160
    ds_read_b64_tr_b16 v[122:123], v22 offset:128
    s_waitcnt lgkmcnt(15)
    v_mfma_f32_16x16x32_f16 v[212:215], v[60:63], v[88:91], v[212:215]
    ds_read_b64 v[216:217], v19 offset:16
    ds_read_b64 v[218:219], v19 offset:24
    v_mfma_f32_16x16x32_f16 v[152:155], v[60:63], v[92:95], v[152:155]
    ds_read_b64_tr_b16 v[124:125], v22 offset:672
    ds_read_b64_tr_b16 v[126:127], v22 offset:640
    v_mfma_f32_16x16x32_f16 v[212:215], v[56:59], v[92:95], v[212:215]
    ds_read_b64 v[220:221], v19 offset:144
    ds_read_b64 v[222:223], v19 offset:152
    s_waitcnt lgkmcnt(15)
    v_mfma_f32_16x16x32_f16 v[152:155], v[64:67], v[88:91], v[152:155]
    ds_read_b64_tr_b16 v[128:129], v22 offset:1184
    ds_read_b64_tr_b16 v[130:131], v22 offset:1152
    v_mfma_f32_16x16x32_f16 v[156:159], v[64:67], v[92:95], v[156:159]
    ds_read_b64 v[224:225], v19 offset:272
    ds_read_b64 v[226:227], v19 offset:280
    v_mfma_f32_16x16x32_f16 v[152:155], v[56:59], v[96:99], v[152:155]
    ds_read_b64_tr_b16 v[132:133], v22 offset:1696
    ds_read_b64_tr_b16 v[134:135], v22 offset:1664
    v_mfma_f32_16x16x32_f16 v[156:159], v[60:63], v[96:99], v[156:159]
    ds_read_b64 v[228:229], v19 offset:400
    ds_read_b64 v[230:231], v19 offset:408
    s_waitcnt lgkmcnt(15)
    v_mfma_f32_16x16x32_f16 v[156:159], v[68:71], v[88:91], v[156:159]
    ds_read_b64_tr_b16 v[136:137], v22 offset:2208
    ds_read_b64_tr_b16 v[138:139], v22 offset:2176
    v_mfma_f32_16x16x32_f16 v[156:159], v[56:59], v[100:103], v[156:159]
    ds_read_b64 v[232:233], v19 offset:528
    ds_read_b64 v[234:235], v19 offset:536
    s_waitcnt lgkmcnt(15)
    v_mfma_f32_16x16x32_f16 v[164:167], v[72:75], v[100:103], v[164:167]
    ds_read_b64_tr_b16 v[140:141], v22 offset:2720
    ds_read_b64_tr_b16 v[142:143], v22 offset:2688
    v_mfma_f32_16x16x32_f16 v[164:167], v[68:71], v[104:107], v[164:167]
    ds_read_b64 v[236:237], v19 offset:656
    ds_read_b64 v[238:239], v19 offset:664
    s_waitcnt lgkmcnt(15)
    v_mfma_f32_16x16x32_f16 v[164:167], v[76:79], v[96:99], v[164:167]
    ds_read_b64_tr_b16 v[144:145], v22 offset:3232
    ds_read_b64_tr_b16 v[146:147], v22 offset:3200
    v_mfma_f32_16x16x32_f16 v[164:167], v[64:67], v[108:111], v[164:167]
    ds_read_b64 v[240:241], v19 offset:784
    ds_read_b64 v[242:243], v19 offset:792
    s_waitcnt lgkmcnt(15)
    v_mfma_f32_16x16x32_f16 v[164:167], v[80:83], v[92:95], v[164:167]
    ds_read_b64_tr_b16 v[148:149], v22 offset:3744
    ds_read_b64_tr_b16 v[150:151], v22 offset:3712
    v_mfma_f32_16x16x32_f16 v[164:167], v[60:63], v[112:115], v[164:167]
    ds_read_b64 v[244:245], v19 offset:912
    ds_read_b64 v[246:247], v19 offset:920
    s_waitcnt lgkmcnt(15)
    v_mfma_f32_16x16x32_f16 v[164:167], v[84:87], v[88:91], v[164:167]
    v_mfma_f32_16x16x32_f16 v[164:167], v[56:59], v[116:119], v[164:167]
    s_waitcnt lgkmcnt(15)
    v_mfma_f32_16x16x32_f16 v[196:199], v[120:123], v[216:219], v[196:199]
    s_waitcnt lgkmcnt(15)
    v_mfma_f32_16x16x32_f16 v[212:215], v[124:127], v[216:219], v[212:215]
    v_mfma_f32_16x16x32_f16 v[152:155], v[124:127], v[220:223], v[152:155]
    v_mfma_f32_16x16x32_f16 v[212:215], v[120:123], v[220:223], v[212:215]
    s_waitcnt lgkmcnt(15)
    v_mfma_f32_16x16x32_f16 v[152:155], v[128:131], v[216:219], v[152:155]
    v_mfma_f32_16x16x32_f16 v[156:159], v[128:131], v[220:223], v[156:159]
    v_mfma_f32_16x16x32_f16 v[152:155], v[120:123], v[224:227], v[152:155]
    v_mfma_f32_16x16x32_f16 v[156:159], v[124:127], v[224:227], v[156:159]
    s_waitcnt lgkmcnt(15)
    v_mfma_f32_16x16x32_f16 v[156:159], v[132:135], v[216:219], v[156:159]
    v_mfma_f32_16x16x32_f16 v[156:159], v[120:123], v[228:231], v[156:159]
    s_waitcnt lgkmcnt(12)
    v_mfma_f32_16x16x32_f16 v[164:167], v[136:139], v[228:231], v[164:167]
    v_mfma_f32_16x16x32_f16 v[164:167], v[132:135], v[232:235], v[164:167]
    s_waitcnt lgkmcnt(8)
    v_mfma_f32_16x16x32_f16 v[164:167], v[140:143], v[224:227], v[164:167]
    v_mfma_f32_16x16x32_f16 v[164:167], v[128:131], v[236:239], v[164:167]
    s_waitcnt lgkmcnt(4)
    v_mfma_f32_16x16x32_f16 v[164:167], v[144:147], v[220:223], v[164:167]
    v_mfma_f32_16x16x32_f16 v[164:167], v[124:127], v[240:243], v[164:167]
    s_waitcnt lgkmcnt(0)
    v_mfma_f32_16x16x32_f16 v[164:167], v[148:151], v[216:219], v[164:167]
    v_mfma_f32_16x16x32_f16 v[164:167], v[120:123], v[244:247], v[164:167]
    s_nop 7
    s_nop 1
    ds_write_b128 v20, v[196:199] offset:0
    ds_write_b128 v20, v[212:215] offset:4096
    ds_write_b128 v20, v[152:155] offset:8192
    ds_write_b128 v20, v[156:159] offset:12288
    ds_write_b128 v20, v[164:167] offset:16384
    s_branch L_sd_50
L_so_49:
    s_waitcnt lgkmcnt(15)
    v_mfma_f32_16x16x32_f16 v[196:199], v[64:67], v[96:99], v[196:199]
    ds_read_b64_tr_b16 v[120:121], v22 offset:160
    ds_read_b64_tr_b16 v[122:123], v22 offset:128
    s_waitcnt lgkmcnt(15)
    v_mfma_f32_16x16x32_f16 v[196:199], v[68:71], v[92:95], v[196:199]
    ds_read_b64 v[216:217], v19 offset:16
    ds_read_b64 v[218:219], v19 offset:24
    v_mfma_f32_16x16x32_f16 v[212:215], v[68:71], v[96:99], v[212:215]
    ds_read_b64_tr_b16 v[124:125], v22 offset:672
    ds_read_b64_tr_b16 v[126:127], v22 offset:640
    v_mfma_f32_16x16x32_f16 v[152:155], v[68:71], v[100:103], v[152:155]
    ds_read_b64 v[220:221], v19 offset:144
    ds_read_b64 v[222:223], v19 offset:152
    v_mfma_f32_16x16x32_f16 v[196:199], v[60:63], v[100:103], v[196:199]
    ds_read_b64_tr_b16 v[128:129], v22 offset:1184
    ds_read_b64_tr_b16 v[130:131], v22 offset:1152
    v_mfma_f32_16x16x32_f16 v[212:215], v[64:67], v[100:103], v[212:215]
    ds_read_b64 v[224:225], v19 offset:272
    ds_read_b64 v[226:227], v19 offset:280
    s_waitcnt lgkmcnt(15)
    v_mfma_f32_16x16x32_f16 v[196:199], v[72:75], v[88:91], v[196:199]
    ds_read_b64_tr_b16 v[132:133], v22 offset:1696
    ds_read_b64_tr_b16 v[134:135], v22 offset:1664
    v_mfma_f32_16x16x32_f16 v[212:215], v[72:75], v[92:95], v[212:215]
    ds_read_b64 v[228:229], v19 offset:400
    ds_read_b64 v[230:231], v19 offset:408
    v_mfma_f32_16x16x32_f16 v[152:155], v[72:75], v[96:99], v[152:155]
    ds_read_b64_tr_b16 v[136:137], v22 offset:2208
    ds_read_b64_tr_b16 v[138:139], v22 offset:2176
    v_mfma_f32_16x16x32_f16 v[196:199], v[56:59], v[104:107], v[196:199]
    ds_read_b64 v[232:233], v19 offset:528
    ds_read_b64 v[234:235], v19 offset:536
    v_mfma_f32_16x16x32_f16 v[212:215], v[60:63], v[104:107], v[212:215]
    ds_read_b64_tr_b16 v[140:141], v22 offset:2720
    ds_read_b64_tr_b16 v[142:143], v22 offset:2688
    v_mfma_f32_16x16x32_f16 v[152:155], v[64:67], v[104:107], v[152:155]
    ds_read_b64 v[236:237], v19 offset:656
    ds_read_b64 v[238:239], v19 offset:664
    s_waitcnt lgkmcnt(15)
    v_mfma_f32_16x16x32_f16 v[212:215], v[76:79], v[88:91], v[212:215]
    ds_read_b64_tr_b16 v[144:145], v22 offset:3232
    ds_read_b64_tr_b16 v[146:147], v22 offset:3200
    v_mfma_f32_16x16x32_f16 v[152:155], v[76:79], v[92:95], v[152:155]
    ds_read_b64 v[240:241], v19 offset:784
    ds_read_b64 v[242:243], v19 offset:792
    v_mfma_f32_16x16x32_f16 v[212:215], v[56:59], v[108:111], v[212:215]
    v_mfma_f32_16x16x32_f16 v[152:155], v[60:63], v[108:111], v[152:155]
    s_waitcnt lgkmcnt(15)
    v_mfma_f32_16x16x32_f16 v[152:155], v[80:83], v[88:91], v[152:155]
    v_mfma_f32_16x16x32_f16 v[152:155], v[56:59], v[112:115], v[152:155]
    s_waitcnt lgkmcnt(15)
    v_mfma_f32_16x16x32_f16 v[196:199], v[128:131], v[224:227], v[196:199]
    s_waitcnt lgkmcnt(12)
    v_mfma_f32_16x16x32_f16 v[196:199], v[132:135], v[220:223], v[196:199]
    v_mfma_f32_16x16x32_f16 v[212:215], v[132:135], v[224:227], v[212:215]
    v_mfma_f32_16x16x32_f16 v[152:155], v[132:135], v[228:231], v[152:155]
    v_mfma_f32_16x16x32_f16 v[196:199], v[124:127], v[228:231], v[196:199]
    v_mfma_f32_16x16x32_f16 v[212:215], v[128:131], v[228:231], v[212:215]
    s_waitcnt lgkmcnt(8)
    v_mfma_f32_16x16x32_f16 v[196:199], v[136:139], v[216:219], v[196:199]
    v_mfma_f32_16x16x32_f16 v[212:215], v[136:139], v[220:223], v[212:215]
    v_mfma_f32_16x16x32_f16 v[152:155], v[136:139], v[224:227], v[152:155]
    v_mfma_f32_16x16x32_f16 v[196:199], v[120:123], v[232:235], v[196:199]
    v_mfma_f32_16x16x32_f16 v[212:215], v[124:127], v[232:235], v[212:215]
    v_mfma_f32_16x16x32_f16 v[152:155], v[128:131], v[232:235], v[152:155]
    s_waitcnt lgkmcnt(4)
    v_mfma_f32_16x16x32_f16 v[212:215], v[140:143], v[216:219], v[212:215]
    v_mfma_f32_16x16x32_f16 v[152:155], v[140:143], v[220:223], v[152:155]
    v_mfma_f32_16x16x32_f16 v[212:215], v[120:123], v[236:239], v[212:215]
    v_mfma_f32_16x16x32_f16 v[152:155], v[124:127], v[236:239], v[152:155]
    s_waitcnt lgkmcnt(0)
    v_mfma_f32_16x16x32_f16 v[152:155], v[144:147], v[216:219], v[152:155]
    v_mfma_f32_16x16x32_f16 v[152:155], v[120:123], v[240:243], v[152:155]
    s_nop 7
    s_nop 1
    ds_write_b128 v20, v[196:199] offset:0
    ds_write_b128 v20, v[212:215] offset:4096
    ds_write_b128 v20, v[152:155] offset:8192
L_sd_50:
    s_cmp_eq_u32 s20, 1
    s_cbranch_scc1 L_rw1_52
    s_cmp_eq_u32 s20, 2
    s_cbranch_scc1 L_rw2_53
    s_cmp_eq_u32 s20, 3
    s_cbranch_scc1 L_rw3_54
L_rw0_51:
    ds_write_b128 v13, v[32:35] offset:2048
    ds_write_b128 v13, v[36:39] offset:3072
    ds_write_b128 v13, v[40:43] offset:4096
    ds_write_b128 v13, v[44:47] offset:5120
    ds_write_b128 v13, v[48:51] offset:6144
    ds_write_b128 v13, v[52:55] offset:7168
    s_waitcnt vmcnt(0) lgkmcnt(0)
    s_barrier
    ds_read_b128 v[56:59], v13 offset:8192
    ds_read_b128 v[60:63], v13 offset:16384
    ds_read_b128 v[64:67], v13 offset:24576
    ds_read_b128 v[68:71], v13 offset:9216
    ds_read_b128 v[72:75], v13 offset:17408
    ds_read_b128 v[76:79], v13 offset:25600
    s_waitcnt lgkmcnt(3)
    v_add_f32 v24, v24, v56
    v_add_f32 v60, v60, v64
    v_add_f32 v25, v25, v57
    v_add_f32 v61, v61, v65
    v_add_f32 v26, v26, v58
    v_add_f32 v62, v62, v66
    v_add_f32 v27, v27, v59
    v_add_f32 v63, v63, v67
    v_fma_f32 v24, s48, v24, 0
    v_fma_f32 v60, s49, v60, 0
    v_fma_f32 v25, s48, v25, 0
    v_fma_f32 v61, s49, v61, 0
    v_fma_f32 v26, s48, v26, 0
    v_fma_f32 v62, s49, v62, 0
    v_fma_f32 v27, s48, v27, 0
    v_fma_f32 v63, s49, v63, 0
    v_cvt_pk_bf16_f32 v88, v24, v25
    v_cvt_pk_bf16_f32 v89, v26, v27
    v_cvt_pk_bf16_f32 v90, v60, v61
    v_cvt_pk_bf16_f32 v91, v62, v63
    v_xor_b32 v88, 0x80008000, v88
    v_xor_b32 v89, 0x80008000, v89
    v_xor_b32 v90, 0x80008000, v90
    v_xor_b32 v91, 0x80008000, v91
    s_nop 0
    v_permlane16_swap_b32 v88, v90
    v_permlane16_swap_b32 v89, v91
    buffer_store_dwordx4 v[88:91], v18, s[32:35], s10 offen offset:0 sc1
    s_waitcnt lgkmcnt(0)
    v_add_f32 v28, v28, v68
    v_add_f32 v72, v72, v76
    v_add_f32 v29, v29, v69
    v_add_f32 v73, v73, v77
    v_add_f32 v30, v30, v70
    v_add_f32 v74, v74, v78
    v_add_f32 v31, v31, v71
    v_add_f32 v75, v75, v79
    v_fma_f32 v28, s48, v28, 0
    v_fma_f32 v72, s49, v72, 0
    v_fma_f32 v29, s48, v29, 0
    v_fma_f32 v73, s49, v73, 0
    v_fma_f32 v30, s48, v30, 0
    v_fma_f32 v74, s49, v74, 0
    v_fma_f32 v31, s48, v31, 0
    v_fma_f32 v75, s49, v75, 0
    v_cvt_pk_bf16_f32 v92, v28, v29
    v_cvt_pk_bf16_f32 v93, v30, v31
    v_cvt_pk_bf16_f32 v94, v72, v73
    v_cvt_pk_bf16_f32 v95, v74, v75
    v_xor_b32 v92, 0x80008000, v92
    v_xor_b32 v93, 0x80008000, v93
    v_xor_b32 v94, 0x80008000, v94
    v_xor_b32 v95, 0x80008000, v95
    s_nop 0
    v_permlane16_swap_b32 v92, v94
    v_permlane16_swap_b32 v93, v95
    buffer_store_dwordx4 v[92:95], v18, s[32:35], s10 offen offset:1024 sc1
    s_branch L_convdone_48
L_rw1_52:
    ds_write_b128 v13, v[24:27] offset:8192
    ds_write_b128 v13, v[28:31] offset:9216
    ds_write_b128 v13, v[40:43] offset:12288
    ds_write_b128 v13, v[44:47] offset:13312
    ds_write_b128 v13, v[48:51] offset:14336
    ds_write_b128 v13, v[52:55] offset:15360
    s_waitcnt vmcnt(0) lgkmcnt(0)
    s_barrier
    ds_read_b128 v[56:59], v13 offset:2048
    ds_read_b128 v[60:63], v13 offset:18432
    ds_read_b128 v[64:67], v13 offset:26624
    ds_read_b128 v[68:71], v13 offset:3072
    ds_read_b128 v[72:75], v13 offset:19456
    ds_read_b128 v[76:79], v13 offset:27648
    s_waitcnt lgkmcnt(3)
    v_add_f32 v32, v32, v56
    v_add_f32 v60, v60, v64
    v_add_f32 v33, v33, v57
    v_add_f32 v61, v61, v65
    v_add_f32 v34, v34, v58
    v_add_f32 v62, v62, v66
    v_add_f32 v35, v35, v59
    v_add_f32 v63, v63, v67
    v_fma_f32 v32, s48, v32, 0
    v_fma_f32 v60, s49, v60, 0
    v_fma_f32 v33, s48, v33, 0
    v_fma_f32 v61, s49, v61, 0
    v_fma_f32 v34, s48, v34, 0
    v_fma_f32 v62, s49, v62, 0
    v_fma_f32 v35, s48, v35, 0
    v_fma_f32 v63, s49, v63, 0
    v_cvt_pk_bf16_f32 v88, v32, v33
    v_cvt_pk_bf16_f32 v89, v34, v35
    v_cvt_pk_bf16_f32 v90, v60, v61
    v_cvt_pk_bf16_f32 v91, v62, v63
    v_xor_b32 v88, 0x80008000, v88
    v_xor_b32 v89, 0x80008000, v89
    v_xor_b32 v90, 0x80008000, v90
    v_xor_b32 v91, 0x80008000, v91
    s_nop 0
    v_permlane16_swap_b32 v88, v90
    v_permlane16_swap_b32 v89, v91
    buffer_store_dwordx4 v[88:91], v18, s[32:35], s10 offen offset:0 sc1
    s_waitcnt lgkmcnt(0)
    v_add_f32 v36, v36, v68
    v_add_f32 v72, v72, v76
    v_add_f32 v37, v37, v69
    v_add_f32 v73, v73, v77
    v_add_f32 v38, v38, v70
    v_add_f32 v74, v74, v78
    v_add_f32 v39, v39, v71
    v_add_f32 v75, v75, v79
    v_fma_f32 v36, s48, v36, 0
    v_fma_f32 v72, s49, v72, 0
    v_fma_f32 v37, s48, v37, 0
    v_fma_f32 v73, s49, v73, 0
    v_fma_f32 v38, s48, v38, 0
    v_fma_f32 v74, s49, v74, 0
    v_fma_f32 v39, s48, v39, 0
    v_fma_f32 v75, s49, v75, 0
    v_cvt_pk_bf16_f32 v92, v36, v37
    v_cvt_pk_bf16_f32 v93, v38, v39
    v_cvt_pk_bf16_f32 v94, v72, v73
    v_cvt_pk_bf16_f32 v95, v74, v75
    v_xor_b32 v92, 0x80008000, v92
    v_xor_b32 v93, 0x80008000, v93
    v_xor_b32 v94, 0x80008000, v94
    v_xor_b32 v95, 0x80008000, v95
    s_nop 0
    v_permlane16_swap_b32 v92, v94
    v_permlane16_swap_b32 v93, v95
    buffer_store_dwordx4 v[92:95], v18, s[32:35], s10 offen offset:1024 sc1
    s_branch L_convdone_48
L_rw2_53:
    ds_write_b128 v13, v[24:27] offset:16384
    ds_write_b128 v13, v[28:31] offset:17408
    ds_write_b128 v13, v[32:35] offset:18432
    ds_write_b128 v13, v[36:39] offset:19456
    ds_write_b128 v13, v[48:51] offset:22528
    ds_write_b128 v13, v[52:55] offset:23552
    s_waitcnt vmcnt(0) lgkmcnt(0)
    s_barrier
    ds_read_b128 v[56:59], v13 offset:28672
    ds_read_b128 v[60:63], v13 offset:4096
    ds_read_b128 v[64:67], v13 offset:12288
    ds_read_b128 v[68:71], v13 offset:29696
    ds_read_b128 v[72:75], v13 offset:5120
    ds_read_b128 v[76:79], v13 offset:13312
    s_waitcnt lgkmcnt(3)
    v_add_f32 v40, v40, v56
    v_add_f32 v60, v60, v64
    v_add_f32 v41, v41, v57
    v_add_f32 v61, v61, v65
    v_add_f32 v42, v42, v58
    v_add_f32 v62, v62, v66
    v_add_f32 v43, v43, v59
    v_add_f32 v63, v63, v67
    v_fma_f32 v60, s48, v60, 0
    v_fma_f32 v40, s49, v40, 0
    v_fma_f32 v61, s48, v61, 0
    v_fma_f32 v41, s49, v41, 0
    v_fma_f32 v62, s48, v62, 0
    v_fma_f32 v42, s49, v42, 0
    v_fma_f32 v63, s48, v63, 0
    v_fma_f32 v43, s49, v43, 0
    v_cvt_pk_bf16_f32 v88, v60, v61
    v_cvt_pk_bf16_f32 v89, v62, v63
    v_cvt_pk_bf16_f32 v90, v40, v41
    v_cvt_pk_bf16_f32 v91, v42, v43
    v_xor_b32 v88, 0x80008000, v88
    v_xor_b32 v89, 0x80008000, v89
    v_xor_b32 v90, 0x80008000, v90
    v_xor_b32 v91, 0x80008000, v91
    s_nop 0
    v_permlane16_swap_b32 v88, v90
    v_permlane16_swap_b32 v89, v91
    buffer_store_dwordx4 v[88:91], v18, s[32:35], s10 offen offset:0 sc1
    s_waitcnt lgkmcnt(0)
    v_add_f32 v44, v44, v68
    v_add_f32 v72, v72, v76
    v_add_f32 v45, v45, v69
    v_add_f32 v73, v73, v77
    v_add_f32 v46, v46, v70
    v_add_f32 v74, v74, v78
    v_add_f32 v47, v47, v71
    v_add_f32 v75, v75, v79
    v_fma_f32 v72, s48, v72, 0
    v_fma_f32 v44, s49, v44, 0
    v_fma_f32 v73, s48, v73, 0
    v_fma_f32 v45, s49, v45, 0
    v_fma_f32 v74, s48, v74, 0
    v_fma_f32 v46, s49, v46, 0
    v_fma_f32 v75, s48, v75, 0
    v_fma_f32 v47, s49, v47, 0
    v_cvt_pk_bf16_f32 v92, v72, v73
    v_cvt_pk_bf16_f32 v93, v74, v75
    v_cvt_pk_bf16_f32 v94, v44, v45
    v_cvt_pk_bf16_f32 v95, v46, v47
    v_xor_b32 v92, 0x80008000, v92
    v_xor_b32 v93, 0x80008000, v93
    v_xor_b32 v94, 0x80008000, v94
    v_xor_b32 v95, 0x80008000, v95
    s_nop 0
    v_permlane16_swap_b32 v92, v94
    v_permlane16_swap_b32 v93, v95
    buffer_store_dwordx4 v[92:95], v18, s[32:35], s10 offen offset:1024 sc1
    s_branch L_convdone_48
L_rw3_54:
    ds_write_b128 v13, v[24:27] offset:24576
    ds_write_b128 v13, v[28:31] offset:25600
    ds_write_b128 v13, v[32:35] offset:26624
    ds_write_b128 v13, v[36:39] offset:27648
    ds_write_b128 v13, v[40:43] offset:28672
    ds_write_b128 v13, v[44:47] offset:29696
    s_waitcnt vmcnt(0) lgkmcnt(0)
    s_barrier
    ds_read_b128 v[56:59], v13 offset:22528
    ds_read_b128 v[60:63], v13 offset:6144
    ds_read_b128 v[64:67], v13 offset:14336
    ds_read_b128 v[68:71], v13 offset:23552
    ds_read_b128 v[72:75], v13 offset:7168
    ds_read_b128 v[76:79], v13 offset:15360
    s_waitcnt lgkmcnt(3)
    v_add_f32 v48, v48, v56
    v_add_f32 v60, v60, v64
    v_add_f32 v49, v49, v57
    v_add_f32 v61, v61, v65
    v_add_f32 v50, v50, v58
    v_add_f32 v62, v62, v66
    v_add_f32 v51, v51, v59
    v_add_f32 v63, v63, v67
    v_fma_f32 v60, s48, v60, 0
    v_fma_f32 v48, s49, v48, 0
    v_fma_f32 v61, s48, v61, 0
    v_fma_f32 v49, s49, v49, 0
    v_fma_f32 v62, s48, v62, 0
    v_fma_f32 v50, s49, v50, 0
    v_fma_f32 v63, s48, v63, 0
    v_fma_f32 v51, s49, v51, 0
    v_cvt_pk_bf16_f32 v88, v60, v61
    v_cvt_pk_bf16_f32 v89, v62, v63
    v_cvt_pk_bf16_f32 v90, v48, v49
    v_cvt_pk_bf16_f32 v91, v50, v51
    v_xor_b32 v88, 0x80008000, v88
    v_xor_b32 v89, 0x80008000, v89
    v_xor_b32 v90, 0x80008000, v90
    v_xor_b32 v91, 0x80008000, v91
    s_nop 0
    v_permlane16_swap_b32 v88, v90
    v_permlane16_swap_b32 v89, v91
    buffer_store_dwordx4 v[88:91], v18, s[32:35], s10 offen offset:0 sc1
    s_waitcnt lgkmcnt(0)
    v_add_f32 v52, v52, v68
    v_add_f32 v72, v72, v76
    v_add_f32 v53, v53, v69
    v_add_f32 v73, v73, v77
    v_add_f32 v54, v54, v70
    v_add_f32 v74, v74, v78
    v_add_f32 v55, v55, v71
    v_add_f32 v75, v75, v79
    v_fma_f32 v72, s48, v72, 0
    v_fma_f32 v52, s49, v52, 0
    v_fma_f32 v73, s48, v73, 0
    v_fma_f32 v53, s49, v53, 0
    v_fma_f32 v74, s48, v74, 0
    v_fma_f32 v54, s49, v54, 0
    v_fma_f32 v75, s48, v75, 0
    v_fma_f32 v55, s49, v55, 0
    v_cvt_pk_bf16_f32 v92, v72, v73
    v_cvt_pk_bf16_f32 v93, v74, v75
    v_cvt_pk_bf16_f32 v94, v52, v53
    v_cvt_pk_bf16_f32 v95, v54, v55
    v_xor_b32 v92, 0x80008000, v92
    v_xor_b32 v93, 0x80008000, v93
    v_xor_b32 v94, 0x80008000, v94
    v_xor_b32 v95, 0x80008000, v95
    s_nop 0
    v_permlane16_swap_b32 v92, v94
    v_permlane16_swap_b32 v93, v95
    buffer_store_dwordx4 v[92:95], v18, s[32:35], s10 offen offset:1024 sc1
    s_branch L_convdone_48
L_shared_47:
    s_waitcnt vmcnt(0)
    buffer_load_dwordx4 v[168:171], v16, s[40:43], s12 offen
    buffer_load_dwordx4 v[172:175], v16, s[40:43], s13 offen
    buffer_load_dwordx4 v[176:179], v16, s[40:43], s14 offen
    buffer_load_dwordx4 v[180:183], v16, s[40:43], s15 offen
    buffer_load_dwordx4 v[184:187], v16, s[40:43], s16 offen
    s_sub_u32 s5, s20, 4
    s_mov_b32 s10, s100
    v_add_u32 v13, 32768, v13
    s_waitcnt vmcnt(5)
    s_barrier
    s_cmp_eq_u32 s61, 1
    s_cbranch_scc1 L_sharedodd_55
    s_cmp_lg_u32 s5, 0
    s_cbranch_scc1 L_nx_56
    ds_read_b128 v[56:59], v13 offset:0
    ds_read_b128 v[60:63], v13 offset:1024
    ds_read_b128 v[64:67], v13 offset:2048
    ds_read_b128 v[68:71], v13 offset:3072
    s_waitcnt lgkmcnt(0)
    v_add_f32 v56, v56, v60
    v_add_f32 v64, v64, v68
    v_add_f32 v24, v56, v64
    v_add_f32 v57, v57, v61
    v_add_f32 v65, v65, v69
    v_add_f32 v25, v57, v65
    v_add_f32 v58, v58, v62
    v_add_f32 v66, v66, v70
    v_add_f32 v26, v58, v66
    v_add_f32 v59, v59, v63
    v_add_f32 v67, v67, v71
    v_add_f32 v27, v59, v67
    v_fma_f32 v24, s50, v24, 0
    v_fma_f32 v25, s50, v25, 0
    v_fma_f32 v26, s50, v26, 0
    v_fma_f32 v27, s50, v27, 0
    v_cvt_pk_bf16_f32 v24, v24, v25
    v_cvt_pk_bf16_f32 v25, v26, v27
    v_xor_b32 v24, 0x80008000, v24
    v_xor_b32 v25, 0x80008000, v25
    buffer_store_dwordx2 v[24:25], v12, s[32:35], s10 offen offset:0 sc1
    ds_read_b128 v[56:59], v13 offset:16384
    ds_read_b128 v[60:63], v13 offset:17408
    ds_read_b128 v[64:67], v13 offset:18432
    ds_read_b128 v[68:71], v13 offset:19456
    s_waitcnt lgkmcnt(0)
    v_add_f32 v56, v56, v60
    v_add_f32 v64, v64, v68
    v_add_f32 v52, v56, v64
    v_add_f32 v57, v57, v61
    v_add_f32 v65, v65, v69
    v_add_f32 v53, v57, v65
    v_add_f32 v58, v58, v62
    v_add_f32 v66, v66, v70
    v_add_f32 v54, v58, v66
    v_add_f32 v59, v59, v63
    v_add_f32 v67, v67, v71
    v_add_f32 v55, v59, v67
    v_fma_f32 v52, s50, v52, 0
    v_fma_f32 v53, s50, v53, 0
    v_fma_f32 v54, s50, v54, 0
    v_fma_f32 v55, s50, v55, 0
    v_cvt_pk_bf16_f32 v52, v52, v53
    v_cvt_pk_bf16_f32 v53, v54, v55
    v_xor_b32 v52, 0x80008000, v52
    v_xor_b32 v53, 0x80008000, v53
    buffer_store_dwordx2 v[52:53], v12, s[32:35], s10 offen offset:3584 sc1
    s_branch L_convdone_48
L_nx_56:
    s_cmp_lg_u32 s5, 1
    s_cbranch_scc1 L_nx_57
    ds_read_b128 v[56:59], v13 offset:4096
    ds_read_b128 v[60:63], v13 offset:5120
    ds_read_b128 v[64:67], v13 offset:6144
    ds_read_b128 v[68:71], v13 offset:7168
    s_waitcnt lgkmcnt(0)
    v_add_f32 v56, v56, v60
    v_add_f32 v64, v64, v68
    v_add_f32 v28, v56, v64
    v_add_f32 v57, v57, v61
    v_add_f32 v65, v65, v69
    v_add_f32 v29, v57, v65
    v_add_f32 v58, v58, v62
    v_add_f32 v66, v66, v70
    v_add_f32 v30, v58, v66
    v_add_f32 v59, v59, v63
    v_add_f32 v67, v67, v71
    v_add_f32 v31, v59, v67
    v_fma_f32 v28, s50, v28, 0
    v_fma_f32 v29, s50, v29, 0
    v_fma_f32 v30, s50, v30, 0
    v_fma_f32 v31, s50, v31, 0
    v_cvt_pk_bf16_f32 v28, v28, v29
    v_cvt_pk_bf16_f32 v29, v30, v31
    v_xor_b32 v28, 0x80008000, v28
    v_xor_b32 v29, 0x80008000, v29
    buffer_store_dwordx2 v[28:29], v12, s[32:35], s10 offen offset:512 sc1
    s_branch L_convdone_48
L_nx_57:
    s_cmp_lg_u32 s5, 2
    s_cbranch_scc1 L_nx_58
    ds_read_b128 v[56:59], v13 offset:8192
    ds_read_b128 v[60:63], v13 offset:9216
    ds_read_b128 v[64:67], v13 offset:10240
    ds_read_b128 v[68:71], v13 offset:11264
    s_waitcnt lgkmcnt(0)
    v_add_f32 v56, v56, v60
    v_add_f32 v64, v64, v68
    v_add_f32 v32, v56, v64
    v_add_f32 v57, v57, v61
    v_add_f32 v65, v65, v69
    v_add_f32 v33, v57, v65
    v_add_f32 v58, v58, v62
    v_add_f32 v66, v66, v70
    v_add_f32 v34, v58, v66
    v_add_f32 v59, v59, v63
    v_add_f32 v67, v67, v71
    v_add_f32 v35, v59, v67
    v_fma_f32 v32, s50, v32, 0
    v_fma_f32 v33, s50, v33, 0
    v_fma_f32 v34, s50, v34, 0
    v_fma_f32 v35, s50, v35, 0
    v_cvt_pk_bf16_f32 v32, v32, v33
    v_cvt_pk_bf16_f32 v33, v34, v35
    v_xor_b32 v32, 0x80008000, v32
    v_xor_b32 v33, 0x80008000, v33
    buffer_store_dwordx2 v[32:33], v12, s[32:35], s10 offen offset:1024 sc1
    s_branch L_convdone_48
L_nx_58:
    s_cmp_lg_u32 s5, 3
    s_cbranch_scc1 L_nx_59
    ds_read_b128 v[56:59], v13 offset:12288
    ds_read_b128 v[60:63], v13 offset:13312
    ds_read_b128 v[64:67], v13 offset:14336
    ds_read_b128 v[68:71], v13 offset:15360
    s_waitcnt lgkmcnt(0)
    v_add_f32 v56, v56, v60
    v_add_f32 v64, v64, v68
    v_add_f32 v36, v56, v64
    v_add_f32 v57, v57, v61
    v_add_f32 v65, v65, v69
    v_add_f32 v37, v57, v65
    v_add_f32 v58, v58, v62
    v_add_f32 v66, v66, v70
    v_add_f32 v38, v58, v66
    v_add_f32 v59, v59, v63
    v_add_f32 v67, v67, v71
    v_add_f32 v39, v59, v67
    v_fma_f32 v36, s50, v36, 0
    v_fma_f32 v37, s50, v37, 0
    v_fma_f32 v38, s50, v38, 0
    v_fma_f32 v39, s50, v39, 0
    v_cvt_pk_bf16_f32 v36, v36, v37
    v_cvt_pk_bf16_f32 v37, v38, v39
    v_xor_b32 v36, 0x80008000, v36
    v_xor_b32 v37, 0x80008000, v37
    buffer_store_dwordx2 v[36:37], v12, s[32:35], s10 offen offset:1536 sc1
    s_branch L_convdone_48
L_nx_59:
    s_branch L_convdone_48
L_sharedodd_55:
    s_cmp_lg_u32 s5, 0
    s_cbranch_scc1 L_nx_60
    ds_read_b128 v[56:59], v13 offset:0
    ds_read_b128 v[60:63], v13 offset:1024
    ds_read_b128 v[64:67], v13 offset:2048
    ds_read_b128 v[68:71], v13 offset:3072
    s_waitcnt lgkmcnt(0)
    v_add_f32 v56, v56, v60
    v_add_f32 v64, v64, v68
    v_add_f32 v40, v56, v64
    v_add_f32 v57, v57, v61
    v_add_f32 v65, v65, v69
    v_add_f32 v41, v57, v65
    v_add_f32 v58, v58, v62
    v_add_f32 v66, v66, v70
    v_add_f32 v42, v58, v66
    v_add_f32 v59, v59, v63
    v_add_f32 v67, v67, v71
    v_add_f32 v43, v59, v67
    v_fma_f32 v40, s50, v40, 0
    v_fma_f32 v41, s50, v41, 0
    v_fma_f32 v42, s50, v42, 0
    v_fma_f32 v43, s50, v43, 0
    v_cvt_pk_bf16_f32 v40, v40, v41
    v_cvt_pk_bf16_f32 v41, v42, v43
    v_xor_b32 v40, 0x80008000, v40
    v_xor_b32 v41, 0x80008000, v41
    buffer_store_dwordx2 v[40:41], v12, s[32:35], s10 offen offset:2048 sc1
    s_branch L_convdone_48
L_nx_60:
    s_cmp_lg_u32 s5, 1
    s_cbranch_scc1 L_nx_61
    ds_read_b128 v[56:59], v13 offset:4096
    ds_read_b128 v[60:63], v13 offset:5120
    ds_read_b128 v[64:67], v13 offset:6144
    ds_read_b128 v[68:71], v13 offset:7168
    s_waitcnt lgkmcnt(0)
    v_add_f32 v56, v56, v60
    v_add_f32 v64, v64, v68
    v_add_f32 v44, v56, v64
    v_add_f32 v57, v57, v61
    v_add_f32 v65, v65, v69
    v_add_f32 v45, v57, v65
    v_add_f32 v58, v58, v62
    v_add_f32 v66, v66, v70
    v_add_f32 v46, v58, v66
    v_add_f32 v59, v59, v63
    v_add_f32 v67, v67, v71
    v_add_f32 v47, v59, v67
    v_fma_f32 v44, s50, v44, 0
    v_fma_f32 v45, s50, v45, 0
    v_fma_f32 v46, s50, v46, 0
    v_fma_f32 v47, s50, v47, 0
    v_cvt_pk_bf16_f32 v44, v44, v45
    v_cvt_pk_bf16_f32 v45, v46, v47
    v_xor_b32 v44, 0x80008000, v44
    v_xor_b32 v45, 0x80008000, v45
    buffer_store_dwordx2 v[44:45], v12, s[32:35], s10 offen offset:2560 sc1
    s_branch L_convdone_48
L_nx_61:
    s_cmp_lg_u32 s5, 2
    s_cbranch_scc1 L_nx_62
    ds_read_b128 v[56:59], v13 offset:8192
    ds_read_b128 v[60:63], v13 offset:9216
    ds_read_b128 v[64:67], v13 offset:10240
    ds_read_b128 v[68:71], v13 offset:11264
    s_waitcnt lgkmcnt(0)
    v_add_f32 v56, v56, v60
    v_add_f32 v64, v64, v68
    v_add_f32 v48, v56, v64
    v_add_f32 v57, v57, v61
    v_add_f32 v65, v65, v69
    v_add_f32 v49, v57, v65
    v_add_f32 v58, v58, v62
    v_add_f32 v66, v66, v70
    v_add_f32 v50, v58, v66
    v_add_f32 v59, v59, v63
    v_add_f32 v67, v67, v71
    v_add_f32 v51, v59, v67
    v_fma_f32 v48, s50, v48, 0
    v_fma_f32 v49, s50, v49, 0
    v_fma_f32 v50, s50, v50, 0
    v_fma_f32 v51, s50, v51, 0
    v_cvt_pk_bf16_f32 v48, v48, v49
    v_cvt_pk_bf16_f32 v49, v50, v51
    v_xor_b32 v48, 0x80008000, v48
    v_xor_b32 v49, 0x80008000, v49
    buffer_store_dwordx2 v[48:49], v12, s[32:35], s10 offen offset:3072 sc1
    s_branch L_convdone_48
L_nx_62:
    s_cmp_lg_u32 s5, 3
    s_cbranch_scc1 L_nx_63
    s_branch L_convdone_48
L_nx_63:
    s_branch L_convdone_48
L_convdone_48:
    s_mov_b32 s36, s72
    s_and_b32 s37, s73, 0xffff
    s_mov_b32 s38, 2621440
    s_mov_b32 s39, 0x00020000
    v_lshrrev_b32 v7, 1, v0
    v_lshlrev_b32 v5, 13, v7
    v_and_b32 v6, 1, v0
    v_lshl_add_u32 v5, v6, 4, v5
    v_lshrrev_b32 v33, 2, v0
    v_mul_u32_u24 v33, 5, v33
    v_add_u32 v6, v6, v33
    v_and_b32 v7, 1, v7
    v_mul_u32_u24 v7, 3, v7
    v_add_u32 v6, v6, v7
    v_lshlrev_b32 v6, 2, v6
    v_lshlrev_b32 v7, 12, v0
    v_mul_u32_u24 v33, 20, v0
    v_add_u32 v33, 8, v33
    s_lshl_b32 s48, s21, 5
    s_add_u32 s48, s48, 2621440
    s_lshl_b32 s49, s21, 4
    s_add_u32 s49, s49, 4718592
    v_cmp_gt_u32 vcc, 128, v0
    s_mov_b64 s[6:7], -1
    s_mov_b64 s[8:9], vcc
    s_mov_b32 s4, 0
L_g_64:
    s_mov_b64 exec, s[6:7]
    s_cbranch_execz L_g1_65
    buffer_load_dwordx4 v[8:11], v5, s[32:35], s48 offen sc1
L_g1_65:
    s_mov_b64 exec, s[8:9]
    s_cbranch_execz L_g2_66
    buffer_load_dwordx4 v[12:15], v7, s[32:35], s49 offen sc1
L_g2_66:
    s_mov_b64 exec, -1
    s_add_u32 s4, s4, 1
    s_waitcnt vmcnt(0)
    v_min_u32 v36, v8, v9
    v_min3_u32 v36, v36, v10, v11
    v_min_u32 v37, v12, v13
    v_min3_u32 v37, v37, v14, v15
    v_cmp_eq_u32 vcc, 0, v36
    v_cmp_eq_u32 s[10:11], 0, v37
    s_and_b64 s[6:7], s[6:7], vcc
    s_and_b64 s[8:9], s[8:9], s[10:11]
    s_cmp_ge_u32 s4, 262144
    s_cbranch_scc1 L_go_67
    s_or_b64 s[10:11], s[6:7], s[8:9]
    s_cbranch_scc1 L_g_64
L_go_67:
    v_cmp_gt_u32 vcc, 128, v0
    ds_write2st64_b32 v6, v8, v9 offset0:0 offset1:10
    ds_write2st64_b32 v6, v10, v11 offset0:20 offset1:30
    s_and_saveexec_b64 s[42:43], vcc
    ds_write2st64_b32 v33, v12, v13 offset0:0 offset1:10
    ds_write2st64_b32 v33, v14, v15 offset0:20 offset1:30
    s_mov_b64 exec, s[42:43]
    s_lshr_b32 s44, s20, 1
    s_mul_i32 s44, s44, 2560
    v_lshlrev_b32 v7, 5, v2
    v_add_u32 v7, s44, v7
    v_lshlrev_b32 v33, 3, v2
    v_add_u32 v33, s44, v33
    s_and_b32 s45, s20, 1
    s_mul_i32 s45, s45, 0x02020000
    s_add_u32 s45, s45, 0x01000c0c
    v_lshlrev_b32 v40, 16, v200
    v_and_b32 v41, 0xffff0000, v200
    v_lshlrev_b32 v50, 16, v206
    v_and_b32 v51, 0xffff0000, v206
    v_lshlrev_b32 v60, 16, v160
    v_and_b32 v61, 0xffff0000, v160
    v_lshlrev_b32 v42, 16, v201
    v_and_b32 v43, 0xffff0000, v201
    v_lshlrev_b32 v52, 16, v207
    v_and_b32 v53, 0xffff0000, v207
    v_lshlrev_b32 v62, 16, v161
    v_and_b32 v63, 0xffff0000, v161
    v_lshlrev_b32 v44, 16, v202
    v_and_b32 v45, 0xffff0000, v202
    v_lshlrev_b32 v54, 16, v208
    v_and_b32 v55, 0xffff0000, v208
    v_lshlrev_b32 v64, 16, v162
    v_and_b32 v65, 0xffff0000, v162
    v_lshlrev_b32 v46, 16, v203
    v_and_b32 v47, 0xffff0000, v203
    v_lshlrev_b32 v56, 16, v209
    v_and_b32 v57, 0xffff0000, v209
    v_lshlrev_b32 v66, 16, v163
    v_and_b32 v67, 0xffff0000, v163
    v_lshlrev_b32 v48, 16, v204
    v_and_b32 v49, 0xffff0000, v204
    v_lshlrev_b32 v58, 16, v210
    v_and_b32 v59, 0xffff0000, v210
    v_lshlrev_b32 v68, 16, v205
    v_and_b32 v69, 0xffff0000, v205
    s_waitcnt lgkmcnt(0)
    s_barrier
    ds_read_b128 v[8:11], v7
    ds_read_b128 v[12:15], v7 offset:16
    ds_read_b64 v[34:35], v33 offset:2048
    s_waitcnt lgkmcnt(0)
    v_perm_b32 v8, v8, v8, s45
    v_perm_b32 v9, v9, v9, s45
    v_perm_b32 v10, v10, v10, s45
    v_perm_b32 v11, v11, v11, s45
    v_perm_b32 v12, v12, v12, s45
    v_perm_b32 v13, v13, v13, s45
    v_perm_b32 v14, v14, v14, s45
    v_perm_b32 v15, v15, v15, s45
    v_perm_b32 v34, v34, v34, s45
    v_perm_b32 v35, v35, v35, s45
    v_sub_f32 v50, v50, v8
    v_sub_f32 v51, v51, v9
    v_cvt_pk_bf16_f32 v36, v50, v51
    v_lshlrev_b32 v50, 16, v36
    v_and_b32 v51, 0xffff0000, v36
    v_add_f32 v50, v40, v50
    v_add_f32 v51, v41, v51
    v_cvt_pk_bf16_f32 v36, v50, v51
    v_lshlrev_b32 v70, 16, v36
    v_and_b32 v71, 0xffff0000, v36
    v_sub_f32 v52, v52, v10
    v_sub_f32 v53, v53, v11
    v_cvt_pk_bf16_f32 v36, v52, v53
    v_lshlrev_b32 v52, 16, v36
    v_and_b32 v53, 0xffff0000, v36
    v_add_f32 v52, v42, v52
    v_add_f32 v53, v43, v53
    v_cvt_pk_bf16_f32 v36, v52, v53
    v_lshlrev_b32 v72, 16, v36
    v_and_b32 v73, 0xffff0000, v36
    v_sub_f32 v54, v54, v12
    v_sub_f32 v55, v55, v13
    v_cvt_pk_bf16_f32 v36, v54, v55
    v_lshlrev_b32 v54, 16, v36
    v_and_b32 v55, 0xffff0000, v36
    v_add_f32 v54, v44, v54
    v_add_f32 v55, v45, v55
    v_cvt_pk_bf16_f32 v36, v54, v55
    v_lshlrev_b32 v74, 16, v36
    v_and_b32 v75, 0xffff0000, v36
    v_sub_f32 v56, v56, v14
    v_sub_f32 v57, v57, v15
    v_cvt_pk_bf16_f32 v36, v56, v57
    v_lshlrev_b32 v56, 16, v36
    v_and_b32 v57, 0xffff0000, v36
    v_add_f32 v56, v46, v56
    v_add_f32 v57, v47, v57
    v_cvt_pk_bf16_f32 v36, v56, v57
    v_lshlrev_b32 v76, 16, v36
    v_and_b32 v77, 0xffff0000, v36
    v_sub_f32 v58, v58, v34
    v_sub_f32 v59, v59, v35
    v_cvt_pk_bf16_f32 v36, v58, v59
    v_lshlrev_b32 v58, 16, v36
    v_and_b32 v59, 0xffff0000, v36
    v_add_f32 v58, v48, v58
    v_add_f32 v59, v49, v59
    v_cvt_pk_bf16_f32 v36, v58, v59
    v_lshlrev_b32 v78, 16, v36
    v_and_b32 v79, 0xffff0000, v36
    v_readfirstlane_b32 s48, v70
    s_nop 1
    v_subrev_f32 v40, s48, v70
    v_subrev_f32 v41, s48, v71
    v_subrev_f32 v42, s48, v72
    v_subrev_f32 v43, s48, v73
    v_subrev_f32 v44, s48, v74
    v_subrev_f32 v45, s48, v75
    v_subrev_f32 v46, s48, v76
    v_subrev_f32 v47, s48, v77
    v_subrev_f32 v48, s48, v78
    v_subrev_f32 v49, s48, v79
    v_add_f32 v36, v40, v41
    v_mul_f32 v21, v40, v40
    v_add_f32 v37, v42, v43
    v_mul_f32 v38, v41, v41
    v_add_f32 v36, v36, v44
    v_add_f32 v37, v37, v45
    v_add_f32 v36, v36, v46
    v_add_f32 v37, v37, v47
    v_add_f32 v36, v36, v48
    v_add_f32 v37, v37, v49
    v_fmac_f32 v21, v42, v42
    v_fmac_f32 v38, v43, v43
    v_fmac_f32 v21, v44, v44
    v_fmac_f32 v38, v45, v45
    v_fmac_f32 v21, v46, v46
    v_fmac_f32 v38, v47, v47
    v_fmac_f32 v21, v48, v48
    v_fmac_f32 v38, v49, v49
    v_add_f32 v36, v36, v37
    v_add_f32 v21, v21, v38
    s_nop 0
    v_add_f32_dpp v36, v36, v36 quad_perm:[1,0,3,2] row_mask:0xf bank_mask:0xf
    v_add_f32_dpp v21, v21, v21 quad_perm:[1,0,3,2] row_mask:0xf bank_mask:0xf
    s_nop 0
    v_add_f32_dpp v36, v36, v36 quad_perm:[2,3,0,1] row_mask:0xf bank_mask:0xf
    v_add_f32_dpp v21, v21, v21 quad_perm:[2,3,0,1] row_mask:0xf bank_mask:0xf
    s_nop 0
    v_add_f32_dpp v36, v36, v36 row_half_mirror row_mask:0xf bank_mask:0xf
    v_add_f32_dpp v21, v21, v21 row_half_mirror row_mask:0xf bank_mask:0xf
    s_nop 0
    v_add_f32_dpp v36, v36, v36 row_mirror row_mask:0xf bank_mask:0xf
    v_add_f32_dpp v21, v21, v21 row_mirror row_mask:0xf bank_mask:0xf
    s_nop 0
    v_add_f32_dpp v36, v36, v36 row_bcast:15 row_mask:0xa bank_mask:0xf
    v_add_f32_dpp v21, v21, v21 row_bcast:15 row_mask:0xa bank_mask:0xf
    s_nop 0
    v_add_f32_dpp v36, v36, v36 row_bcast:31 row_mask:0xc bank_mask:0xf
    v_add_f32_dpp v21, v21, v21 row_bcast:31 row_mask:0xc bank_mask:0xf
    v_mov_b32 v39, 0x3acccccd
    v_readlane_b32 s46, v36, 63
    v_readlane_b32 s47, v21, 63
    s_nop 0
    v_mul_f32 v37, s46, v39
    v_mul_f32 v38, s47, v39
    v_fma_f32 v38, -v37, v37, v38
    v_add_f32 v37, s48, v37
    v_max_f32 v38, 0, v38
    v_cvt_pk_bf16_f32 v39, v38, v38
    v_lshlrev_b32 v38, 16, v39
    v_add_f32 v38, 0x3727c5ac, v38
    v_cvt_pk_bf16_f32 v39, v38, v38
    v_lshlrev_b32 v38, 16, v39
    v_sqrt_f32 v38, v38
    s_nop 0
    v_cvt_pk_bf16_f32 v39, v38, v38
    v_lshlrev_b32 v38, 16, v39
    v_rcp_f32 v38, v38
    v_cvt_pk_bf16_f32 v39, v37, v37
    v_lshlrev_b32 v37, 16, v39
    v_mov_b32 v36, 0
    v_mov_b32 v21, 0
    v_sub_f32 v40, v70, v37
    v_sub_f32 v41, v71, v37
    v_cvt_pk_bf16_f32 v39, v40, v41
    v_lshlrev_b32 v40, 16, v39
    v_and_b32 v41, 0xffff0000, v39
    v_mul_f32 v40, v40, v38
    v_mul_f32 v41, v41, v38
    v_cvt_pk_bf16_f32 v39, v40, v41
    v_lshlrev_b32 v40, 16, v39
    v_and_b32 v41, 0xffff0000, v39
    v_fmac_f32 v36, v40, v60
    v_fmac_f32 v21, v41, v61
    v_sub_f32 v42, v72, v37
    v_sub_f32 v43, v73, v37
    v_cvt_pk_bf16_f32 v39, v42, v43
    v_lshlrev_b32 v42, 16, v39
    v_and_b32 v43, 0xffff0000, v39
    v_mul_f32 v42, v42, v38
    v_mul_f32 v43, v43, v38
    v_cvt_pk_bf16_f32 v39, v42, v43
    v_lshlrev_b32 v42, 16, v39
    v_and_b32 v43, 0xffff0000, v39
    v_fmac_f32 v36, v42, v62
    v_fmac_f32 v21, v43, v63
    v_sub_f32 v44, v74, v37
    v_sub_f32 v45, v75, v37
    v_cvt_pk_bf16_f32 v39, v44, v45
    v_lshlrev_b32 v44, 16, v39
    v_and_b32 v45, 0xffff0000, v39
    v_mul_f32 v44, v44, v38
    v_mul_f32 v45, v45, v38
    v_cvt_pk_bf16_f32 v39, v44, v45
    v_lshlrev_b32 v44, 16, v39
    v_and_b32 v45, 0xffff0000, v39
    v_fmac_f32 v36, v44, v64
    v_fmac_f32 v21, v45, v65
    v_sub_f32 v46, v76, v37
    v_sub_f32 v47, v77, v37
    v_cvt_pk_bf16_f32 v39, v46, v47
    v_lshlrev_b32 v46, 16, v39
    v_and_b32 v47, 0xffff0000, v39
    v_mul_f32 v46, v46, v38
    v_mul_f32 v47, v47, v38
    v_cvt_pk_bf16_f32 v39, v46, v47
    v_lshlrev_b32 v46, 16, v39
    v_and_b32 v47, 0xffff0000, v39
    v_fmac_f32 v36, v46, v66
    v_fmac_f32 v21, v47, v67
    v_sub_f32 v48, v78, v37
    v_sub_f32 v49, v79, v37
    v_cvt_pk_bf16_f32 v39, v48, v49
    v_lshlrev_b32 v48, 16, v39
    v_and_b32 v49, 0xffff0000, v39
    v_mul_f32 v48, v48, v38
    v_mul_f32 v49, v49, v38
    v_cvt_pk_bf16_f32 v39, v48, v49
    v_lshlrev_b32 v48, 16, v39
    v_and_b32 v49, 0xffff0000, v39
    v_fmac_f32 v36, v48, v68
    v_fmac_f32 v21, v49, v69
    v_add_f32 v36, v36, v21
    s_nop 1
    v_add_f32_dpp v36, v36, v36 quad_perm:[1,0,3,2] row_mask:0xf bank_mask:0xf
    s_nop 1
    v_add_f32_dpp v36, v36, v36 quad_perm:[2,3,0,1] row_mask:0xf bank_mask:0xf
    s_nop 1
    v_add_f32_dpp v36, v36, v36 row_half_mirror row_mask:0xf bank_mask:0xf
    s_nop 1
    v_add_f32_dpp v36, v36, v36 row_mirror row_mask:0xf bank_mask:0xf
    s_nop 1
    v_add_f32_dpp v36, v36, v36 row_bcast:15 row_mask:0xa bank_mask:0xf
    s_nop 1
    v_add_f32_dpp v36, v36, v36 row_bcast:31 row_mask:0xc bank_mask:0xf
    v_cvt_pk_bf16_f32 v36, v36, v36
    v_and_b32 v36, 0xffff, v36
    v_xor_b32 v37, 0xffff, v36
    v_or_b32 v38, 0x8000, v36
    v_cmp_lt_u32 vcc, 0x7fff, v36
    s_sub_u32 s46, 4095, s22
    s_lshl_b32 s49, s20, 2
    v_cndmask_b32 v36, v38, v37, vcc
    v_lshl_or_b32 v36, v36, 16, s46
    s_add_u32 s49, s49, 121664
    v_mov_b32 v37, s49
    v_readlane_b32 s48, v36, 63
    s_nop 1
    v_mov_b32 v38, s48
    ds_write_b32 v37, v38
    v_add_f32 v50, v70, v40
    v_add_f32 v51, v71, v41
    v_cvt_pk_bf16_f32 v92, v50, v51
    v_add_f32 v52, v72, v42
    v_add_f32 v53, v73, v43
    v_cvt_pk_bf16_f32 v93, v52, v53
    v_add_f32 v54, v74, v44
    v_add_f32 v55, v75, v45
    v_cvt_pk_bf16_f32 v94, v54, v55
    v_add_f32 v56, v76, v46
    v_add_f32 v57, v77, v47
    v_cvt_pk_bf16_f32 v95, v56, v57
    v_add_f32 v58, v78, v48
    v_add_f32 v59, v79, v49
    v_cvt_pk_bf16_f32 v96, v58, v59
    v_and_b32 v37, 7, v2
    v_lshlrev_b32 v37, 2, v37
    v_add_u32 v37, 121664, v37
    s_waitcnt lgkmcnt(0)
    s_barrier
    ds_read_b32 v38, v37
    s_waitcnt lgkmcnt(0)
    s_nop 1
    v_max_u32_dpp v38, v38, v38 quad_perm:[1,0,3,2] row_mask:0xf bank_mask:0xf
    s_nop 1
    v_max_u32_dpp v38, v38, v38 quad_perm:[2,3,0,1] row_mask:0xf bank_mask:0xf
    s_nop 1
    v_max_u32_dpp v38, v38, v38 row_half_mirror row_mask:0xf bank_mask:0xf
    s_nop 0
    v_readfirstlane_b32 s50, v38
    s_cmp_lg_u32 s50, s48
    s_cbranch_scc1 L_notbest_68
    s_lshl_b32 s51, s21, 4
    s_add_u32 s51, s51, 5242880
    v_mov_b32 v37, 0
    s_mov_b64 exec, 1
    buffer_store_dword v38, v37, s[32:35], s51 offen sc1
    s_mov_b64 exec, -1
    v_or_b32 v40, 1, v40
    v_or_b32 v70, 1, v70
    v_or_b32 v41, 1, v41
    v_or_b32 v71, 1, v71
    v_or_b32 v42, 1, v42
    v_or_b32 v72, 1, v72
    v_or_b32 v43, 1, v43
    v_or_b32 v73, 1, v73
    v_or_b32 v44, 1, v44
    v_or_b32 v74, 1, v74
    v_or_b32 v45, 1, v45
    v_or_b32 v75, 1, v75
    v_or_b32 v46, 1, v46
    v_or_b32 v76, 1, v76
    v_or_b32 v47, 1, v47
    v_or_b32 v77, 1, v77
    v_or_b32 v48, 1, v48
    v_or_b32 v78, 1, v78
    v_or_b32 v49, 1, v49
    v_or_b32 v79, 1, v79
    s_mul_i32 s51, s21, 5120
    s_add_u32 s51, s51, 5373952
    v_lshlrev_b32 v37, 5, v2
    v_lshlrev_b32 v39, 3, v2
    buffer_store_dwordx4 v[40:43], v37, s[32:35], s51 offen sc1
    buffer_store_dwordx4 v[44:47], v37, s[32:35], s51 offen offset:16 sc1
    buffer_store_dwordx2 v[48:49], v39, s[32:35], s51 offen offset:2048 sc1
    s_add_u32 s51, s51, 2560
    buffer_store_dwordx4 v[70:73], v37, s[32:35], s51 offen sc1
    buffer_store_dwordx4 v[74:77], v37, s[32:35], s51 offen offset:16 sc1
    buffer_store_dwordx2 v[78:79], v39, s[32:35], s51 offen offset:2048 sc1
    s_branch L_poll_69
L_notbest_68:
    buffer_store_dwordx4 v[92:95], v3, s[36:39], s23 offen nt
    buffer_store_dword v96, v4, s[36:39], s23 offen offset:1024 nt
L_poll_69:
    v_lshlrev_b32 v100, 16, v168
    v_and_b32 v101, 0xffff0000, v168
    v_lshlrev_b32 v102, 16, v169
    v_and_b32 v103, 0xffff0000, v169
    v_lshlrev_b32 v104, 16, v170
    v_and_b32 v105, 0xffff0000, v170
    v_lshlrev_b32 v106, 16, v171
    v_and_b32 v107, 0xffff0000, v171
    v_lshlrev_b32 v108, 16, v172
    v_and_b32 v109, 0xffff0000, v172
    v_lshlrev_b32 v110, 16, v173
    v_and_b32 v111, 0xffff0000, v173
    v_lshlrev_b32 v112, 16, v174
    v_and_b32 v113, 0xffff0000, v174
    v_lshlrev_b32 v114, 16, v175
    v_and_b32 v115, 0xffff0000, v175
    v_lshlrev_b32 v116, 16, v176
    v_and_b32 v117, 0xffff0000, v176
    v_lshlrev_b32 v118, 16, v177
    v_and_b32 v119, 0xffff0000, v177
    v_lshlrev_b32 v120, 16, v178
    v_and_b32 v121, 0xffff0000, v178
    v_lshlrev_b32 v122, 16, v179
    v_and_b32 v123, 0xffff0000, v179
    v_lshlrev_b32 v124, 16, v180
    v_and_b32 v125, 0xffff0000, v180
    v_lshlrev_b32 v126, 16, v181
    v_and_b32 v127, 0xffff0000, v181
    v_lshlrev_b32 v128, 16, v182
    v_and_b32 v129, 0xffff0000, v182
    v_lshlrev_b32 v130, 16, v183
    v_and_b32 v131, 0xffff0000, v183
    v_lshlrev_b32 v132, 16, v184
    v_and_b32 v133, 0xffff0000, v184
    v_lshlrev_b32 v134, 16, v185
    v_and_b32 v135, 0xffff0000, v185
    v_lshlrev_b32 v136, 16, v186
    v_and_b32 v137, 0xffff0000, v186
    v_lshlrev_b32 v138, 16, v187
    v_and_b32 v139, 0xffff0000, v187
    v_lshlrev_b32 v140, 16, v188
    v_and_b32 v141, 0xffff0000, v188
    v_lshlrev_b32 v142, 16, v189
    v_and_b32 v143, 0xffff0000, v189
    v_lshlrev_b32 v144, 16, v190
    v_and_b32 v145, 0xffff0000, v190
    v_lshlrev_b32 v146, 16, v191
    v_and_b32 v147, 0xffff0000, v191
    v_lshlrev_b32 v148, 16, v192
    v_and_b32 v149, 0xffff0000, v192
    v_lshlrev_b32 v150, 16, v193
    v_and_b32 v151, 0xffff0000, v193
    v_lshlrev_b32 v152, 16, v194
    v_and_b32 v153, 0xffff0000, v194
    v_lshlrev_b32 v154, 16, v195
    v_and_b32 v155, 0xffff0000, v195
    s_mov_b32 s58, s48
    s_mov_b32 s59, s50
    s_mov_b32 s56, 0
L_attempt_74:
    s_cmp_lg_u32 s20, 0
    s_cbranch_scc1 L_b2_70
    s_cmp_lg_u32 s2, 255
    s_cbranch_scc1 L_kslave_71
    s_mov_b32 s5, 5242880
    s_mov_b32 s6, 5244928
    s_mov_b32 s4, 0
    s_mov_b32 s7, 0
    v_lshlrev_b32 v14, 12, v2
    s_mov_b32 s9, 5275776
L_m_77:
    buffer_load_dword v8, v3, s[32:35], s5 offen sc1
    buffer_load_dword v9, v3, s[32:35], s5 offen offset:1024 sc1
    buffer_load_dword v10, v3, s[32:35], s6 offen sc1
    buffer_load_dword v11, v3, s[32:35], s6 offen offset:1024 sc1
    s_add_u32 s4, s4, 1
    s_waitcnt vmcnt(0)
    v_cmp_ne_u32 vcc, 0, v8
    v_cmp_ne_u32 s[10:11], 0, v9
    s_bcnt1_i32_b64 s8, vcc
    s_bcnt1_i32_b64 s12, s[10:11]
    v_cmp_ne_u32 vcc, 0, v10
    v_cmp_ne_u32 s[10:11], 0, v11
    s_add_u32 s8, s8, s12
    s_bcnt1_i32_b64 s12, vcc
    s_add_u32 s8, s8, s12
    s_bcnt1_i32_b64 s12, s[10:11]
    s_add_u32 s8, s8, s12
    s_cmp_ge_u32 s4, 262144
    s_cselect_b32 s8, 256, s8
    s_cmp_lt_u32 s8, 176
    s_cbranch_scc1 L_m_77
    s_cmp_eq_u32 s8, 256
    s_cbranch_scc1 L_mn_79
    s_cmp_lg_u32 s7, 0
    s_cbranch_scc1 L_m_77
L_mn_79:
    v_max_u32 v12, v8, v9
    v_max3_u32 v12, v12, v10, v11
    s_nop 1
    v_max_u32_dpp v12, v12, v12 quad_perm:[1,0,3,2] row_mask:0xf bank_mask:0xf
    s_nop 1
    v_max_u32_dpp v12, v12, v12 quad_perm:[2,3,0,1] row_mask:0xf bank_mask:0xf
    s_nop 1
    v_max_u32_dpp v12, v12, v12 row_half_mirror row_mask:0xf bank_mask:0xf
    s_nop 1
    v_max_u32_dpp v12, v12, v12 row_mirror row_mask:0xf bank_mask:0xf
    s_nop 1
    v_max_u32_dpp v12, v12, v12 row_bcast:15 row_mask:0xa bank_mask:0xf
    s_nop 1
    v_max_u32_dpp v12, v12, v12 row_bcast:31 row_mask:0xc bank_mask:0xf
    s_nop 0
    v_readlane_b32 s12, v12, 63
    s_cmp_eq_u32 s7, 0
    s_cselect_b32 s7, s12, s7
    s_cmp_eq_u32 s8, 256
    s_cselect_b32 s12, s12, 0
    v_mov_b32 v8, s7
    v_mov_b32 v9, s12
    s_mov_b64 exec, 0xff
    buffer_store_dwordx2 v[8:9], v14, s[32:35], s9 offen sc1
    s_mov_b64 exec, -1
    s_cmp_eq_u32 s8, 256
    s_cbranch_scc0 L_m_77
    s_branch L_kd_72
L_kslave_71:
    s_and_b32 s5, s2, 7
    s_lshl_b32 s5, s5, 12
    s_add_u32 s5, s5, 5275776
    v_mov_b32 v46, 0
    s_cmp_lt_u32 s2, 216
    s_cselect_b32 s6, -1, 0
    s_cmp_eq_u32 s56, 0
    s_cselect_b32 s6, s6, 0
    s_mov_b32 s4, 0
L_spin_80:
    buffer_load_dwordx2 v[8:9], v46, s[32:35], s5 offen sc1
    s_waitcnt vmcnt(0)
    v_and_b32 v10, s6, v8
    v_or_b32 v10, v10, v9
    v_cmp_ne_u32 vcc, 0, v10
    s_add_u32 s4, s4, 1
    s_cmp_ge_u32 s4, 262144
    s_cbranch_scc1 L_spinout_81
    s_cmp_eq_u64 vcc, exec
    s_cbranch_scc1 L_spinout_81
    s_branch L_spin_80
L_spinout_81:
L_kd_72:
    v_mov_b32 v10, 121696
    s_mov_b64 exec, 1
    ds_write_b64 v10, v[8:9]
    s_mov_b64 exec, -1
    s_waitcnt lgkmcnt(0)
L_b2_70:
    s_barrier
    v_mov_b32 v10, 121696
    ds_read_b64 v[8:9], v10
    s_waitcnt lgkmcnt(0)
    v_readfirstlane_b32 s57, v8
    v_readfirstlane_b32 s44, v9
    s_cmp_eq_u32 s44, 0
    s_cbranch_scc1 L_iswin_82
    s_cmp_lg_u32 s59, s58
    s_cbranch_scc1 L_iswin_82
    s_cmp_eq_u32 s44, s58
    s_cbranch_scc1 L_iswin_82
    buffer_store_dwordx4 v[92:95], v3, s[36:39], s23 offen nt
    buffer_store_dword v96, v4, s[36:39], s23 offen offset:1024 nt
L_iswin_82:
    s_mov_b32 s51, s44
    s_cmp_eq_u32 s44, 0
    s_cselect_b32 s44, s57, s44
    s_cmp_eq_u32 s44, s56
    s_cbranch_scc1 L_end
    s_mov_b32 s56, s44
    s_cmp_eq_u32 s44, s57
    s_cselect_b32 s19, 0, 1048576
    s_and_b32 s45, s44, 0x7ff
    s_sub_u32 s45, 2047, s45
    s_lshr_b32 s46, s45, 3
    s_mul_i32 s46, s46, 5120
    s_add_u32 s46, s46, 5373952
    s_cmp_ge_u32 s2, 216
    s_cbranch_scc1 L_down_83
    s_cmp_lt_u32 s20, 4
    s_cbranch_scc1 L_gb_76
    s_lshl_b32 s47, s54, 2
    s_add_u32 s47, s47, s46
    s_mov_b32 s4, 0
L_spin_84:
    buffer_load_dword v12, v4, s[32:35], s47 offen sc1
    buffer_load_dword v13, v4, s[32:35], s47 offen offset:256 sc1
    buffer_load_dword v14, v4, s[32:35], s47 offen offset:512 sc1
    buffer_load_dword v15, v4, s[32:35], s47 offen offset:768 sc1
    buffer_load_dword v16, v4, s[32:35], s47 offen offset:1024 sc1
    s_waitcnt vmcnt(0)
    v_and_b32 v17, v12, v13
    v_and_b32 v18, v14, v15
    v_and_b32 v17, v17, v16
    v_and_b32 v17, v17, v18
    v_and_b32 v17, 1, v17
    v_cmp_ne_u32 vcc, 0, v17
    s_add_u32 s4, s4, 1
    s_cmp_ge_u32 s4, 262144
    s_cbranch_scc1 L_spinout_85
    s_cmp_eq_u64 vcc, exec
    s_cbranch_scc1 L_spinout_85
    s_branch L_spin_84
L_spinout_85:
    v_and_b32 v12, 0xffff0000, v12
    v_and_b32 v13, 0xffff0000, v13
    v_and_b32 v14, 0xffff0000, v14
    v_and_b32 v15, 0xffff0000, v15
    v_and_b32 v16, 0xffff0000, v16
    v_mul_f32 v40, v12, v100
    v_mul_f32 v41, v12, v101
    v_mul_f32 v42, v12, v102
    v_mul_f32 v43, v12, v103
    v_mul_f32 v44, v12, v104
    v_mul_f32 v45, v12, v105
    v_mul_f32 v46, v12, v106
    v_mul_f32 v47, v12, v107
    v_fmac_f32 v40, v13, v108
    v_fmac_f32 v41, v13, v109
    v_fmac_f32 v42, v13, v110
    v_fmac_f32 v43, v13, v111
    v_fmac_f32 v44, v13, v112
    v_fmac_f32 v45, v13, v113
    v_fmac_f32 v46, v13, v114
    v_fmac_f32 v47, v13, v115
    v_fmac_f32 v40, v14, v116
    v_fmac_f32 v41, v14, v117
    v_fmac_f32 v42, v14, v118
    v_fmac_f32 v43, v14, v119
    v_fmac_f32 v44, v14, v120
    v_fmac_f32 v45, v14, v121
    v_fmac_f32 v46, v14, v122
    v_fmac_f32 v47, v14, v123
    v_fmac_f32 v40, v15, v124
    v_fmac_f32 v41, v15, v125
    v_fmac_f32 v42, v15, v126
    v_fmac_f32 v43, v15, v127
    v_fmac_f32 v44, v15, v128
    v_fmac_f32 v45, v15, v129
    v_fmac_f32 v46, v15, v130
    v_fmac_f32 v47, v15, v131
    v_fmac_f32 v40, v16, v132
    v_fmac_f32 v41, v16, v133
    v_fmac_f32 v42, v16, v134
    v_fmac_f32 v43, v16, v135
    v_fmac_f32 v44, v16, v136
    v_fmac_f32 v45, v16, v137
    v_fmac_f32 v46, v16, v138
    v_fmac_f32 v47, v16, v139
    s_nop 1
    v_permlane32_swap_b32 v40, v44
    v_permlane32_swap_b32 v41, v45
    v_permlane32_swap_b32 v42, v46
    v_permlane32_swap_b32 v43, v47
    v_add_f32 v40, v40, v44
    v_add_f32 v41, v41, v45
    v_add_f32 v42, v42, v46
    v_add_f32 v43, v43, v47
    s_nop 1
    v_permlane16_swap_b32 v40, v42
    v_permlane16_swap_b32 v41, v43
    v_add_f32 v40, v40, v42
    v_add_f32 v41, v41, v43
    s_nop 0
    v_add_f32_dpp v40, v40, v40 quad_perm:[1,0,3,2] row_mask:0xf bank_mask:0xf
    v_add_f32_dpp v41, v41, v41 quad_perm:[1,0,3,2] row_mask:0xf bank_mask:0xf
    s_nop 0
    v_add_f32_dpp v40, v40, v40 quad_perm:[2,3,0,1] row_mask:0xf bank_mask:0xf
    v_add_f32_dpp v41, v41, v41 quad_perm:[2,3,0,1] row_mask:0xf bank_mask:0xf
    s_nop 0
    v_add_f32_dpp v40, v40, v40 row_half_mirror row_mask:0xf bank_mask:0xf
    v_add_f32_dpp v41, v41, v41 row_half_mirror row_mask:0xf bank_mask:0xf
    s_nop 0
    v_add_f32_dpp v40, v40, v40 row_mirror row_mask:0xf bank_mask:0xf
    v_add_f32_dpp v41, v41, v41 row_mirror row_mask:0xf bank_mask:0xf
    v_lshrrev_b32 v6, 4, v2
    v_lshlrev_b32 v6, 3, v6
    s_lshl_b32 s47, s20, 5
    s_add_u32 s47, s47, 122528
    v_add_u32 v6, s47, v6
    s_mov_b32 exec_lo, 0x00010001
    s_mov_b32 exec_hi, 0x00010001
    ds_write_b64 v6, v[40:41]
    s_mov_b64 exec, -1
    s_waitcnt lgkmcnt(0)
L_gb_76:
    s_barrier
    s_cmp_ge_u32 s20, 5
    s_cbranch_scc1 L_post_75
    v_and_b32 v6, 7, v2
    v_lshlrev_b32 v6, 2, v6
    v_add_u32 v6, 122656, v6
    ds_read_b32 v8, v6
    ds_read_b32 v9, v6 offset:64
    ds_read_b32 v12, v6 offset:32
    ds_read_b32 v13, v6 offset:96
    s_mul_i32 s47, s2, 2560
    s_lshl_b32 s48, s20, 9
    s_add_u32 s47, s47, s48
    s_add_u32 s47, s47, 7077888
    s_add_u32 s47, s47, s19
    v_lshlrev_b32 v5, 3, v2
    s_waitcnt lgkmcnt(0)
    v_add_f32 v8, v8, v9
    v_add_f32 v12, v12, v13
    v_cvt_pk_bf16_f32 v9, v8, v8
    v_lshlrev_b32 v8, 16, v9
    v_cvt_pk_bf16_f32 v9, v12, v12
    v_lshlrev_b32 v12, 16, v9
    v_mul_f32 v9, 0xbfb8aa3b, v8
    v_exp_f32 v9, v9
    s_nop 0
    v_add_f32 v9, 1.0, v9
    v_rcp_f32 v9, v9
    s_nop 0
    v_mul_f32 v8, v8, v9
    v_cvt_pk_bf16_f32 v9, v8, v8
    v_lshlrev_b32 v8, 16, v9
    v_mul_f32 v8, v8, v12
    v_cvt_pk_bf16_f32 v9, v8, v8
    v_lshlrev_b32 v8, 16, v9
    s_nop 0
    v_readlane_b32 s4, v8, 0
    v_readlane_b32 s5, v8, 1
    v_readlane_b32 s6, v8, 2
    v_readlane_b32 s7, v8, 3
    v_readlane_b32 s8, v8, 4
    v_readlane_b32 s9, v8, 5
    v_readlane_b32 s10, v8, 6
    v_readlane_b32 s11, v8, 7
    s_nop 1
    v_mul_f32 v10, s4, v140
    v_mul_f32 v11, s4, v141
    v_fmac_f32 v10, s5, v142
    v_fmac_f32 v11, s5, v143
    v_fmac_f32 v10, s6, v144
    v_fmac_f32 v11, s6, v145
    v_fmac_f32 v10, s7, v146
    v_fmac_f32 v11, s7, v147
    v_fmac_f32 v10, s8, v148
    v_fmac_f32 v11, s8, v149
    v_fmac_f32 v10, s9, v150
    v_fmac_f32 v11, s9, v151
    v_fmac_f32 v10, s10, v152
    v_fmac_f32 v11, s10, v153
    v_fmac_f32 v10, s11, v154
    v_fmac_f32 v11, s11, v155
    v_or_b32 v10, 1, v10
    v_or_b32 v11, 1, v11
    buffer_store_dwordx2 v[10:11], v5, s[32:35], s47 offen sc1
L_post_75:
    s_cmp_eq_u32 s51, 0
    s_cbranch_scc1 L_attempt_74
    s_branch L_end
L_down_83:
    s_sub_u32 s53, s2, 216
    v_lshrrev_b32 v5, 2, v0
    v_mul_u32_u24 v5, 2560, v5
    v_and_b32 v6, 3, v0
    v_lshl_add_u32 v5, v6, 4, v5
    v_mov_b32 v7, 0x7ffffff0
    v_cmp_gt_u32 vcc, 352, v0
    v_mov_b32 v8, 1
    s_lshl_b32 s47, s53, 6
    v_cndmask_b32 v6, v7, v5, vcc
    v_cndmask_b32 v7, v8, 0, vcc
    s_add_u32 s55, s47, s46
    s_add_u32 s47, s47, 7077888
    s_add_u32 s47, s47, s19
    s_add_u32 s48, s47, 327680
    v_and_b32 v22, 15, v2
    v_lshlrev_b32 v22, 2, v22
    s_mov_b32 s4, 0
L_spin_86:
    buffer_load_dword v20, v22, s[32:35], s55 offen sc1
    buffer_load_dword v21, v22, s[32:35], s55 offen offset:2560 sc1
    s_waitcnt vmcnt(0)
    v_and_b32 v16, v20, v21
    v_and_b32 v16, 1, v16
    v_cmp_ne_u32 vcc, 0, v16
    s_add_u32 s4, s4, 1
    s_cmp_ge_u32 s4, 262144
    s_cbranch_scc1 L_spinout_87
    s_cmp_eq_u64 vcc, exec
    s_cbranch_scc1 L_spinout_87
    s_branch L_spin_86
L_spinout_87:
    v_mov_b32 v12, 0
    v_mov_b32 v13, 0
    v_mov_b32 v14, 0
    v_mov_b32 v15, 0
    v_cmp_gt_u32 vcc, 352, v0
    s_mov_b64 s[6:7], -1
    s_mov_b64 s[8:9], vcc
    s_mov_b32 s4, 0
L_f_88:
    s_mov_b64 exec, s[6:7]
    s_cbranch_execz L_f1_89
    buffer_load_dwordx4 v[8:11], v5, s[32:35], s47 offen sc1
L_f1_89:
    s_mov_b64 exec, s[8:9]
    s_cbranch_execz L_f2_90
    buffer_load_dwordx4 v[12:15], v5, s[32:35], s48 offen sc1
L_f2_90:
    s_mov_b64 exec, -1
    s_add_u32 s4, s4, 1
    s_waitcnt vmcnt(0)
    v_and_b32 v16, v8, v9
    v_and_b32 v17, v10, v11
    v_and_b32 v18, v12, v13
    v_and_b32 v19, v14, v15
    v_and_b32 v16, v16, v17
    v_and_b32 v18, v18, v19
    v_and_b32 v16, 1, v16
    v_and_b32 v18, 1, v18
    v_cmp_eq_u32 vcc, 0, v16
    v_cmp_eq_u32 s[10:11], 0, v18
    s_and_b64 s[6:7], s[6:7], vcc
    s_and_b64 s[8:9], s[8:9], s[10:11]
    s_cmp_ge_u32 s4, 262144
    s_cbranch_scc1 L_fo_91
    s_or_b64 s[10:11], s[6:7], s[8:9]
    s_cbranch_scc1 L_f_88
L_fo_91:
    v_add_f32 v8, v8, v12
    v_add_f32 v9, v9, v13
    v_add_f32 v10, v10, v14
    v_add_f32 v11, v11, v15
    v_and_b32 v20, 0xffff0000, v20
    v_and_b32 v21, 0xffff0000, v21
    v_permlane32_swap_b32 v8, v10
    v_permlane32_swap_b32 v9, v11
    v_add_f32 v8, v8, v10
    v_add_f32 v9, v9, v11
    s_nop 1
    v_permlane16_swap_b32 v8, v9
    v_add_f32 v8, v8, v9
    s_nop 1
    v_add_f32_dpp v8, v8, v8 row_ror:4 row_mask:0xf bank_mask:0xf
    s_nop 1
    v_add_f32_dpp v8, v8, v8 row_ror:8 row_mask:0xf bank_mask:0xf
    v_and_b32 v7, 3, v2
    v_lshlrev_b32 v7, 4, v7
    v_lshrrev_b32 v9, 4, v2
    v_lshl_add_u32 v7, v9, 2, v7
    s_lshl_b32 s47, s20, 6
    s_add_u32 s47, s47, 122016
    v_add_u32 v7, s47, v7
    s_mov_b32 exec_lo, 0x000f000f
    s_mov_b32 exec_hi, 0x000f000f
    ds_write_b32 v7, v8
    s_mov_b64 exec, -1
    s_waitcnt lgkmcnt(0)
    s_barrier
    s_cmp_lg_u32 s20, 0
    s_cbranch_scc1 L_end
    v_add_u32 v6, 122016, v22
    ds_read_b32 v8, v6
    ds_read_b32 v9, v6 offset:64
    ds_read_b32 v10, v6 offset:128
    ds_read_b32 v11, v6 offset:192
    ds_read_b32 v12, v6 offset:256
    ds_read_b32 v13, v6 offset:320
    ds_read_b32 v14, v6 offset:384
    ds_read_b32 v15, v6 offset:448
    s_lshr_b32 s48, s44, 16
    s_xor_b32 s49, s48, 0xffff
    s_and_b32 s50, s48, 0x7fff
    s_cmp_ge_u32 s48, 0x8000
    s_cselect_b32 s48, s50, s49
    s_lshl_b32 s48, s48, 16
    v_mov_b32 v18, s48
    v_mul_f32 v18, 0xbfb8aa3b, v18
    v_exp_f32 v18, v18
    s_nop 0
    v_add_f32 v18, 1.0, v18
    v_rcp_f32 v18, v18
    s_waitcnt lgkmcnt(0)
    v_add_f32 v8, v8, v9
    v_add_f32 v10, v10, v11
    v_add_f32 v12, v12, v13
    v_add_f32 v14, v14, v15
    v_add_f32 v8, v8, v10
    v_add_f32 v12, v12, v14
    v_add_f32 v8, v8, v12
    v_cvt_pk_bf16_f32 v9, v8, v8
    v_lshlrev_b32 v8, 16, v9
    v_cvt_pk_bf16_f32 v9, v18, v18
    v_lshlrev_b32 v18, 16, v9
    v_mul_f32 v8, v8, v18
    v_cvt_pk_bf16_f32 v9, v8, v8
    v_lshlrev_b32 v8, 16, v9
    v_add_f32 v8, v20, v8
    v_cvt_pk_bf16_f32 v9, v8, v8
    v_lshlrev_b32 v8, 16, v9
    v_add_f32 v8, v21, v8
    v_cvt_pk_bf16_f32 v8, v8, v8
    s_mul_i32 s45, s45, 1280
    s_lshl_b32 s47, s53, 5
    s_add_u32 s45, s45, s47
    v_lshlrev_b32 v7, 1, v2
    s_mov_b64 exec, 0xffff
    buffer_store_short v8, v7, s[36:39], s45 offen
    s_mov_b64 exec, -1
L_end:
L_endx:
    s_endpgm
.section .rodata,"a"
.p2align 6
.amdhsa_kernel sequential_preLN__ssm_conv_s4d__moe_arch_mod__prompt_kernel
  .amdhsa_next_free_vgpr 248
  .amdhsa_next_free_sgpr 102
  .amdhsa_accum_offset 248
  .amdhsa_group_segment_fixed_size 0
  .amdhsa_kernarg_size 120
  .amdhsa_user_sgpr_count 2
  .amdhsa_user_sgpr_kernarg_segment_ptr 1
  .amdhsa_system_sgpr_workgroup_id_x 1
.end_amdhsa_kernel
```
